```python
import torch

def _softmax(x, axis=-1):
    return torch.softmax(x, dim=axis)
def _gelu(x):
    return torch.nn.functional.gelu(x, approximate="tanh")
def _silu(x):
    return torch.nn.functional.silu(x)
def _sigmoid(x):
    return torch.sigmoid(x)
def _layernorm(x, axis=-1, eps=1e-5):
    m = x.mean(dim=axis, keepdim=True)
    v = x.var(dim=axis, keepdim=True, unbiased=False)
    return (x - m) / torch.sqrt(v + eps)
def _scatter_add(tgt, idx, src, axis=0):
    return tgt.clone().index_add_(axis, idx, src)
def _segment_sum(src, seg, n):
    out = torch.zeros((n,) + src.shape[1:], dtype=src.dtype)
    return out.index_add_(0, seg, src)
def _pad(x, pw):
    flat = tuple(v for pair in reversed(pw) for v in pair)
    return torch.nn.functional.pad(x, flat)

kernel_name = 'recurrent_scan__spectral_fnet__geglu_ffn__prompt'

def setup_inputs():

    _w = (lambda a: (lambda t: t.to(torch.bfloat16) if t.is_floating_point() else t)(torch.as_tensor(a)))
    def _A_setup():
        B, S, D = 1, 2048, 512
        ns = torch.arange(S)[:, None] * torch.arange(S)[None, :]
        nd = torch.arange(D)[:, None] * torch.arange(D)[None, :]
        Ws_re = torch.cos(-2.0 * torch.pi * ns / S).to(float)
        Ws_im = torch.sin(-2.0 * torch.pi * ns / S).to(float)
        Wd_re = torch.cos(-2.0 * torch.pi * nd / D).to(float)
        Wd_im = torch.sin(-2.0 * torch.pi * nd / D).to(float)
        return {
            "x": _w((lambda *s: torch.randn(*s, dtype=torch.bfloat16) * 0.05)(B, S, D)),
            "dft_seq_re": _w(Ws_re),
            "dft_seq_im": _w(Ws_im),
            "dft_hid_re": _w(Wd_re),
            "dft_hid_im": _w(Wd_im),
        }
    _A_in = _A_setup()

    def _B_setup():
        B, S, D, F = 1, 2048, 512, 1792
        return {
            "x": _w((lambda *s: torch.randn(*s, dtype=torch.bfloat16) * 0.05)(B, S, D)),
            "w_gate": _w((lambda *s: torch.randn(*s, dtype=torch.bfloat16) * 0.05)(D, F)),
            "w_up": _w((lambda *s: torch.randn(*s, dtype=torch.bfloat16) * 0.05)(D, F)),
            "w_down": _w((lambda *s: torch.randn(*s, dtype=torch.bfloat16) * 0.05)(F, D)),
        }
    _B_in = _B_setup()

    return {
        "A_x": _A_in["x"],
        "A_dft_seq_re": _A_in["dft_seq_re"],
        "A_dft_seq_im": _A_in["dft_seq_im"],
        "A_dft_hid_re": _A_in["dft_hid_re"],
        "A_dft_hid_im": _A_in["dft_hid_im"],
        "B_x": _B_in["x"],
        "B_w_gate": _B_in["w_gate"],
        "B_w_up": _B_in["w_up"],
        "B_w_down": _B_in["w_down"],
    }

def reference(A_x, A_dft_seq_re, A_dft_seq_im, A_dft_hid_re, A_dft_hid_im, B_x, B_w_gate, B_w_up, B_w_down):
    def _A_ref(x, dft_seq_re, dft_seq_im, dft_hid_re, dft_hid_im):
        a = torch.einsum("bsd,ed->bse", x, dft_hid_re)
        b = torch.einsum("bsd,ed->bse", x, dft_hid_im)
        y = torch.einsum("ts,bse->bte", dft_seq_re, a) - torch.einsum("ts,bse->bte", dft_seq_im, b)
        return y

    def _B_ref(x, w_gate, w_up, w_down):
        return (_gelu(x @ w_gate) * (x @ w_up)) @ w_down

    x = A_x
    xn = _layernorm(x, axis=-1)
    s = _A_ref(xn, A_dft_seq_re, A_dft_seq_im, A_dft_hid_re, A_dft_hid_im)
    g = _silu(_B_ref(xn, B_w_gate, B_w_up, B_w_down))
    return x + s * g
```

```asm
; @launch grid=(256,1,1) block=(512,1,1) lds=163840
.amdgcn_target "amdgcn-amd-amdhsa--gfx950"
.text
.globl recurrent_scan__spectral_fnet__geglu_ffn__prompt_kernel
.p2align 8
.type recurrent_scan__spectral_fnet__geglu_ffn__prompt_kernel,@function
recurrent_scan__spectral_fnet__geglu_ffn__prompt_kernel:
L_start:
    s_cmp_ge_u32 s2, 256
    s_cbranch_scc1 L_end
    s_load_dwordx16 s[16:31], s[0:1], 0
    s_load_dwordx8 s[32:39], s[0:1], 64
    s_getpc_b64 s[12:13]
    s_bfe_u32 s10, s2, 0x40003
    s_lshl_b32 s10, s10, 11
    v_and_b32 v2, 15, v0
    v_lshl_add_u32 v2, v2, 7, s10
    v_min_u32 v2, 0x6f84, v2
    global_load_dword v60, v2, s[12:13]
    v_and_b32 v1, 63, v0
    v_lshrrev_b32 v2, 6, v0
    s_nop 0
    v_readfirstlane_b32 s3, v2
    s_and_b32 s10, s2, 7
    s_lshr_b32 s11, s2, 3
    s_and_b32 s6, s10, 1
    s_lshl_b32 s6, s6, 3
    s_and_b32 s14, s11, 7
    s_add_u32 s6, s6, s14
    s_lshr_b32 s7, s10, 1
    s_lshl_b32 s7, s7, 2
    s_lshr_b32 s15, s11, 3
    s_add_u32 s7, s7, s15
    s_mov_b32 s10, 0
    s_cmp_eq_u32 s7, 3
    s_cselect_b32 s10, 13, s10
    s_cmp_eq_u32 s7, 14
    s_cselect_b32 s10, 13, s10
    s_cmp_eq_u32 s7, 7
    s_cselect_b32 s10, 8, s10
    s_cmp_eq_u32 s7, 15
    s_cselect_b32 s10, 8, s10
    s_xor_b32 s7, s7, s10
    s_lshr_b32 s4, s3, 2
    s_and_b32 s5, s3, 3
    s_lshl_b32 s8, s3, 11
    s_mov_b32 s84, 0
    s_add_u32 s10, s6, s7
    s_and_b32 s10, s10, 1
    s_mul_i32 s76, s10, 512
    s_and_b32 s10, s2, 7
    s_lshl_b32 s10, s10, 7
    s_add_u32 s76, s76, s10
    s_and_b32 s76, s76, 0x3ff
    v_lshrrev_b32 v2, 3, v1
    v_lshrrev_b32 v3, 4, v1
    v_and_b32 v4, 7, v1
    v_xor_b32 v4, v4, v3
    v_lshlrev_b32 v4, 4, v4
    s_and_b32 s10, s3, 1
    s_lshl_b32 s10, s10, 4
    v_add_u32 v5, s10, v2
    v_lshlrev_b32 v5, 16, v5
    s_lshl_b32 s12, s6, 2
    s_lshr_b32 s11, s3, 1
    s_add_u32 s10, s12, s11
    s_lshl_b32 s10, s10, 10
    v_add3_u32 v8, v5, v4, s10
    v_xor_b32 v9, 64, v8
    v_add_u32 v9, 0x80000, v9
    s_cmp_ge_u32 s7, 14
    s_cbranch_scc1 L_dft
    s_lshl_b32 s9, s3, 10
    v_and_b32 v5, 7, v1
    v_and_b32 v6, 1, v3
    v_lshlrev_b32 v6, 2, v6
    v_xor_b32 v5, v5, v6
    v_lshlrev_b32 v5, 4, v5
    s_lshl_b32 s11, s3, 3
    v_add_u32 v6, s11, v2
    v_mul_u32_u24 v6, 3584, v6
    s_lshl_b32 s11, s7, 8
    v_add3_u32 v10, v6, v5, s11
    s_waitcnt lgkmcnt(0)
    s_mov_b32 s40, s16
    s_mov_b32 s41, s17
    s_mov_b32 s42, 0x200000
    s_mov_b32 s43, 0x00020000
    s_mov_b32 s44, s28
    s_mov_b32 s45, s29
    s_mov_b32 s46, 0x1c0000
    s_mov_b32 s47, 0x00020000
    s_mov_b32 s48, s30
    s_mov_b32 s49, s31
    s_mov_b32 s50, 0x1c0000
    s_mov_b32 s51, 0x00020000
    s_add_u32 m0, s8, 0
    s_add_u32 s11, s76, 0
    s_and_b32 s11, s11, 0x3ff
    s_mul_i32 s10, s11, 1792
    buffer_load_dwordx4 v8, s[40:43], s11 offen lds
    s_add_u32 m0, s8, 1024
    s_nop 0
    buffer_load_dwordx4 v9, s[40:43], s11 offen lds
    s_add_u32 m0, s9, 16384
    s_nop 0
    buffer_load_dwordx4 v10, s[44:47], s10 offen lds
    s_add_u32 m0, s9, 24576
    s_nop 0
    buffer_load_dwordx4 v10, s[48:51], s10 offen lds
    s_lshr_b32 s13, s3, 1
    s_and_b32 s14, s3, 1
    s_lshl_b32 s11, s14, 1
    s_xor_b32 s11, s11, s13
    v_and_b32 v5, 31, v1
    v_lshrrev_b32 v6, 5, v1
    v_bfe_u32 v7, v1, 1, 3
    v_xor_b32 v7, v7, v6
    s_lshl_b32 s12, s13, 12
    v_lshl_add_u32 v2, v5, 7, s12
    v_bfe_u32 v3, v1, 2, 2
    v_lshl_add_u32 v4, v6, 3, v3
    v_lshlrev_b32 v4, 7, v4
    v_bfe_u32 v3, v1, 3, 1
    v_xor_b32 v3, s14, v3
    v_lshl_add_u32 v4, v3, 6, v4
    v_bfe_u32 v3, v1, 4, 1
    v_lshl_add_u32 v4, v3, 5, v4
    v_and_b32 v3, 3, v1
    v_lshl_add_u32 v4, v3, 3, v4
    s_xor_b32 s12, s11, 0
    s_lshl_b32 s15, s12, 1
    v_xor_b32 v3, s15, v7
    v_lshl_add_u32 v12, v3, 4, v2
    s_lshl_b32 s15, s12, 11
    v_add_u32 v16, s15, v4
    s_xor_b32 s12, s11, 1
    s_lshl_b32 s15, s12, 1
    v_xor_b32 v3, s15, v7
    v_lshl_add_u32 v13, v3, 4, v2
    s_lshl_b32 s15, s12, 11
    v_add_u32 v17, s15, v4
    s_xor_b32 s12, s11, 2
    s_lshl_b32 s15, s12, 1
    v_xor_b32 v3, s15, v7
    v_lshl_add_u32 v14, v3, 4, v2
    s_lshl_b32 s15, s12, 11
    v_add_u32 v18, s15, v4
    s_xor_b32 s12, s11, 3
    s_lshl_b32 s15, s12, 1
    v_xor_b32 v3, s15, v7
    v_lshl_add_u32 v15, v3, 4, v2
    s_lshl_b32 s15, s12, 11
    v_add_u32 v19, s15, v4
    v_lshlrev_b32 v62, 3, v0
    v_lshl_add_u32 v3, v6, 2, s14
    v_lshl_add_u32 v3, v3, 6, v5
    v_lshlrev_b32 v63, 3, v3
    v_mov_b32 v20, 0
    v_mov_b32 v21, 0
    v_mov_b32 v22, 0
    v_mov_b32 v23, 0
    v_mov_b32 v96, 0
    v_mov_b32 v97, 0
    v_mov_b32 v98, 0
    v_mov_b32 v99, 0
    v_mov_b32 v100, 0
    v_mov_b32 v101, 0
    v_mov_b32 v102, 0
    v_mov_b32 v103, 0
    v_mov_b32 v104, 0
    v_mov_b32 v105, 0
    v_mov_b32 v106, 0
    v_mov_b32 v107, 0
    s_mov_b32 vcc_lo, 0x10100101
    s_mov_b32 vcc_hi, 0x10100101
    v_mov_b32 v2, 0x3f803f80
    s_mov_b32 vcc_lo, 0x3030303
    s_mov_b32 vcc_hi, 0xc0c0c0c
    v_cndmask_b32 v24, 0, v2, vcc
    s_mov_b32 vcc_lo, 0x3030303
    s_mov_b32 vcc_hi, 0xc0c0c0c
    v_cndmask_b32 v25, 0, v2, vcc
    s_mov_b32 vcc_lo, 0x30303030
    s_mov_b32 vcc_hi, 0xc0c0c0c0
    v_cndmask_b32 v26, 0, v2, vcc
    s_mov_b32 vcc_lo, 0x30303030
    s_mov_b32 vcc_hi, 0xc0c0c0c0
    v_cndmask_b32 v27, 0, v2, vcc
    v_and_b32 v3, 1, v1
    v_mul_u32_u24 v3, 0xaaaa, v3
    v_or_b32 v32, 0x4444, v3
    v_mov_b32 v28, 0
    v_mov_b32 v112, 0
    v_mov_b32 v29, 0
    v_mov_b32 v113, 0
    v_mov_b32 v30, 0
    v_mov_b32 v114, 0
    v_mov_b32 v31, 0
    v_mov_b32 v115, 0
    s_mov_b32 s52, s38
    s_mov_b32 s53, s39
    s_mov_b32 s54, 0x1000000
    s_mov_b32 s55, 0x00020000
    s_mov_b32 s56, s18
    s_mov_b32 s57, s19
    s_mov_b32 s58, 0x800000
    s_mov_b32 s59, 0x00020000
    s_mov_b32 s60, s20
    s_mov_b32 s61, s21
    s_mov_b32 s62, 0x800000
    s_mov_b32 s63, 0x00020000
    s_mov_b32 s64, s32
    s_mov_b32 s65, s33
    s_mov_b32 s66, 0x1c0000
    s_mov_b32 s67, 0x00020000
    s_mov_b32 s68, s34
    s_mov_b32 s69, s35
    s_mov_b32 s70, 0x200000
    s_mov_b32 s71, 0x00020000
    s_mov_b32 s72, s36
    s_mov_b32 s73, s37
    s_mov_b32 s74, 0x100
    s_mov_b32 s75, 0x00020000
    s_and_b32 s15, s2, 7
    s_lshl_b32 s10, s15, 2
    s_lshr_b32 s28, s2, 3
    s_and_b32 s11, s28, 3
    s_add_u32 s10, s10, s11
    s_lshr_b32 s28, s28, 2
    s_lshl_b32 s11, s11, 1
    s_add_u32 s11, s28, s11
    s_lshr_b32 s12, s10, 1
    s_sub_u32 s13, 32, s12
    s_cmp_eq_u32 s12, 0
    s_cselect_b32 s13, 16, s13
    s_bitcmp1_b32 s10, 0
    s_cselect_b32 s12, s13, s12
    s_lshl_b32 s23, s4, 5
    s_add_u32 s23, s23, s12
    s_lshr_b32 s24, s28, 2
    s_sub_u32 s25, 0, s24
    s_mul_i32 s81, s23, 114688
    s_add_u32 s79, s81, 4096
    s_lshl_b32 s80, s5, 11
    s_lshl_b32 s15, s4, 10
    s_add_u32 s80, s80, s15
    s_lshl_b32 s85, s5, 10
    s_lshl_b32 s15, s4, 12
    s_add_u32 s85, s85, s15
    s_lshl_b32 s26, s28, 6
    s_lshl_b32 s15, s5, 4
    s_add_u32 s26, s26, s15
    s_cmp_lt_u32 s10, 2
    s_cselect_b32 s15, 0, s24
    s_xor_b32 s10, s10, s15
    s_and_b32 s15, s10, 1
    s_lshl_b32 s15, s15, 3
    s_lshr_b32 s10, s10, 1
    s_mul_i32 s27, s10, 147456
    s_add_u32 s27, s27, s15
    s_mul_i32 s15, s5, 7
    s_lshr_b32 s15, s15, 1
    s_lshl_b32 s82, 15, s15
    s_lshl_b32 s10, s6, 4
    s_add_u32 s10, s10, s7
    s_lshl_b32 s10, s10, 7
    s_add_u32 s10, s10, 12582912
    s_cmp_eq_u32 s3, 0
    s_cselect_b32 s30, s10, -1
    s_mov_b32 s10, s11
    s_and_b32 s11, s2, 7
    s_add_u32 s10, s10, s11
    s_cmp_ge_u32 s10, 14
    s_cselect_b32 s11, 14, 0
    s_sub_u32 s10, s10, s11
    s_cmp_ge_u32 s10, 7
    s_cselect_b32 s11, 7, 0
    s_sub_u32 s10, s10, s11
    s_mul_i32 s11, s5, 14
    s_lshl_b32 s12, s10, 1
    s_add_u32 s12, s12, s11
    s_andn2_b32 s13, s12, 3
    s_add_u32 s12, s12, s13
    s_lshl_b32 s16, s12, 14
    s_add_u32 s10, s10, 1
    s_cmp_eq_u32 s10, 7
    s_cselect_b32 s10, 0, s10
    s_lshl_b32 s12, s10, 1
    s_add_u32 s12, s12, s11
    s_andn2_b32 s13, s12, 3
    s_add_u32 s12, s12, s13
    s_lshl_b32 s17, s12, 14
    s_add_u32 s10, s10, 1
    s_cmp_eq_u32 s10, 7
    s_cselect_b32 s10, 0, s10
    s_lshl_b32 s12, s10, 1
    s_add_u32 s12, s12, s11
    s_andn2_b32 s13, s12, 3
    s_add_u32 s12, s12, s13
    s_lshl_b32 s18, s12, 14
    s_add_u32 s10, s10, 1
    s_cmp_eq_u32 s10, 7
    s_cselect_b32 s10, 0, s10
    s_lshl_b32 s12, s10, 1
    s_add_u32 s12, s12, s11
    s_andn2_b32 s13, s12, 3
    s_add_u32 s12, s12, s13
    s_lshl_b32 s19, s12, 14
    s_add_u32 s10, s10, 1
    s_cmp_eq_u32 s10, 7
    s_cselect_b32 s10, 0, s10
    s_lshl_b32 s12, s10, 1
    s_add_u32 s12, s12, s11
    s_andn2_b32 s13, s12, 3
    s_add_u32 s12, s12, s13
    s_lshl_b32 s20, s12, 14
    s_add_u32 s10, s10, 1
    s_cmp_eq_u32 s10, 7
    s_cselect_b32 s10, 0, s10
    s_lshl_b32 s12, s10, 1
    s_add_u32 s12, s12, s11
    s_andn2_b32 s13, s12, 3
    s_add_u32 s12, s12, s13
    s_lshl_b32 s21, s12, 14
    s_add_u32 s10, s10, 1
    s_cmp_eq_u32 s10, 7
    s_cselect_b32 s10, 0, s10
    s_lshl_b32 s12, s10, 1
    s_add_u32 s12, s12, s11
    s_andn2_b32 s13, s12, 3
    s_add_u32 s12, s12, s13
    s_lshl_b32 s22, s12, 14
    s_add_u32 s10, s10, 1
    s_cmp_eq_u32 s10, 7
    s_cselect_b32 s10, 0, s10
    s_lshl_b32 s10, s6, 2
    s_lshr_b32 s11, s3, 1
    s_add_u32 s10, s10, s11
    s_mul_i32 s10, s10, 112
    s_lshl_b32 s11, s7, 3
    s_add_u32 s10, s10, s11
    s_and_b32 s11, s3, 1
    s_lshl_b32 s11, s11, 1
    s_add_u32 s10, s10, s11
    s_lshl_b32 s29, s10, 10
    v_and_b32 v2, 7, v1
    v_bfe_u32 v3, v1, 4, 1
    v_lshlrev_b32 v3, 2, v3
    v_xor_b32 v2, v2, v3
    v_lshlrev_b32 v2, 4, v2
    v_lshrrev_b32 v3, 3, v1
    v_lshl_add_u32 v2, v3, 10, v2
    s_lshl_b32 s14, s4, 13
    s_lshl_b32 s15, s28, 7
    s_add_u32 s15, s15, s14
    v_add_u32 v11, s15, v2
    s_add_u32 m0, s8, 32768
    s_add_u32 s11, s76, 128
    s_and_b32 s11, s11, 0x3ff
    s_mul_i32 s10, s11, 1792
    buffer_load_dwordx4 v8, s[40:43], s11 offen lds
    s_add_u32 m0, s8, 33792
    s_nop 0
    buffer_load_dwordx4 v9, s[40:43], s11 offen lds
    s_add_u32 m0, s9, 49152
    s_nop 0
    buffer_load_dwordx4 v10, s[44:47], s10 offen lds
    s_add_u32 m0, s9, 57344
    s_nop 0
    buffer_load_dwordx4 v10, s[48:51], s10 offen lds
    s_waitcnt vmcnt(4)
    s_barrier
    ds_read_b128 v[128:131], v12 offset:0
    ds_read_b64_tr_b16 v[36:37], v16 offset:16384
    ds_read_b64_tr_b16 v[38:39], v16 offset:16896
    ds_read_b64_tr_b16 v[40:41], v16 offset:24576
    ds_read_b64_tr_b16 v[42:43], v16 offset:25088
    ds_read_b128 v[132:135], v13 offset:0
    ds_read_b64_tr_b16 v[44:45], v17 offset:16384
    ds_read_b64_tr_b16 v[46:47], v17 offset:16896
    ds_read_b64_tr_b16 v[48:49], v17 offset:24576
    ds_read_b64_tr_b16 v[50:51], v17 offset:25088
    s_waitcnt lgkmcnt(5)
    v_mfma_f32_32x32x16_bf16 v[64:79], v[36:39], v[128:131], 0
    ds_read_b128 v[136:139], v14 offset:0
    ds_read_b64_tr_b16 v[52:53], v18 offset:16384
    ds_read_b64_tr_b16 v[54:55], v18 offset:16896
    v_mfma_f32_32x32x16_bf16 v[80:95], v[40:43], v[128:131], 0
    ds_read_b64_tr_b16 v[56:57], v18 offset:24576
    ds_read_b64_tr_b16 v[58:59], v18 offset:25088
    s_waitcnt lgkmcnt(5)
    v_mfma_f32_32x32x16_bf16 v[64:79], v[44:47], v[132:135], v[64:79]
    ds_read_b128 v[140:143], v15 offset:0
    ds_read_b64_tr_b16 v[36:37], v19 offset:16384
    ds_read_b64_tr_b16 v[38:39], v19 offset:16896
    v_mfma_f32_32x32x16_bf16 v[80:95], v[48:51], v[132:135], v[80:95]
    ds_read_b64_tr_b16 v[40:41], v19 offset:24576
    ds_read_b64_tr_b16 v[42:43], v19 offset:25088
    v_mfma_f32_4x4x4_16b_bf16 v[116:119], v[128:129], v[128:129], 0
    v_mfma_f32_4x4x4_16b_bf16 v[120:123], v[130:131], v[130:131], 0
    v_smfmac_f32_16x16x64_bf16 v[28:31], v[24:27], v[44:51], v32
    v_smfmac_f32_16x16x64_bf16 v[112:115], v[24:27], v[128:135], v32
    v_mfma_f32_4x4x4_16b_bf16 v[116:119], v[132:133], v[132:133], v[116:119]
    v_mfma_f32_4x4x4_16b_bf16 v[120:123], v[134:135], v[134:135], v[120:123]
    s_add_u32 m0, s8, 65536
    s_add_u32 s11, s76, 256
    s_and_b32 s11, s11, 0x3ff
    s_mul_i32 s10, s11, 1792
    buffer_load_dwordx4 v8, s[40:43], s11 offen lds
    s_add_u32 m0, s8, 66560
    s_nop 0
    buffer_load_dwordx4 v9, s[40:43], s11 offen lds
    s_add_u32 m0, s9, 81920
    s_nop 0
    buffer_load_dwordx4 v10, s[44:47], s10 offen lds
    s_add_u32 m0, s9, 90112
    s_nop 0
    buffer_load_dwordx4 v10, s[48:51], s10 offen lds
    v_min_u32 v61, 13, v1
    s_lshr_b32 s83, s2, 3
    s_bfe_u32 s78, s83, 0x10003
    s_bfe_u32 s77, s83, 0x10004
    s_xor_b32 s78, s78, s77
    s_mul_i32 s78, s78, 24
    s_xor_b32 s83, s83, s78
    s_and_b32 s77, s83, 0
    s_lshl_b32 s83, s83, 3
    s_add_u32 s83, s83, s3
    s_mul_i32 s83, s83, 14336
    v_lshl_add_u32 v61, v61, 7, s83
    s_add_u32 s77, s77, s2
    s_and_b32 s77, s77, 0
    s_and_b32 s83, s2, 7
    s_mul_i32 s83, s83, 8
    s_lshr_b32 s83, s83, 3
    s_mul_i32 s83, s83, 1792
    s_and_b32 s12, s2, 7
    s_lshl_b32 s12, s12, 1
    s_bfe_u32 s13, s2, 0x10005
    s_add_u32 s12, s12, s13
    s_sub_u32 s13, 32, s12
    s_cmp_eq_u32 s12, 0
    s_cselect_b32 s13, 16, s13
    s_bitcmp1_b32 s2, 4
    s_cselect_b32 s12, s13, s12
    s_bfe_u32 s13, s2, 0x10003
    s_lshl_b32 s13, s13, 3
    s_add_u32 s13, s13, s3
    s_lshl_b32 s13, s13, 7
    s_add_u32 s12, s12, s13
    s_lshr_b32 s13, s2, 6
    s_cmp_eq_u32 s13, 1
    s_cselect_b32 s12, s12, 0x4000
    v_bfe_u32 v2, v1, 3, 2
    v_lshl_add_u32 v2, v2, 5, s12
    v_lshlrev_b32 v126, 12, v2
    v_and_b32 v3, 7, v1
    v_lshlrev_b32 v3, 7, v3
    v_lshl_add_u32 v127, v2, 10, v3
    s_waitcnt vmcnt(4) lgkmcnt(0)
    s_barrier
    v_mfma_f32_32x32x16_bf16 v[64:79], v[52:55], v[136:139], v[64:79]
    ds_read_b128 v[144:147], v12 offset:32768
    ds_read_b64_tr_b16 v[44:45], v16 offset:49152
    ds_read_b64_tr_b16 v[46:47], v16 offset:49664
    v_mfma_f32_32x32x16_bf16 v[80:95], v[56:59], v[136:139], v[80:95]
    ds_read_b64_tr_b16 v[48:49], v16 offset:57344
    ds_read_b64_tr_b16 v[50:51], v16 offset:57856
    v_xor_b32 v12, 0x10000, v12
    v_xor_b32 v16, 65536, v16
    s_add_u32 m0, s8, 98304
    s_add_u32 s11, s76, 384
    s_and_b32 s11, s11, 0x3ff
    s_mul_i32 s10, s11, 1792
    buffer_load_dwordx4 v8, s[40:43], s11 offen lds
    s_add_u32 m0, s8, 99328
    s_nop 0
    buffer_load_dwordx4 v9, s[40:43], s11 offen lds
    s_waitcnt lgkmcnt(5)
    v_mfma_f32_32x32x16_bf16 v[64:79], v[36:39], v[140:143], v[64:79]
    ds_read_b128 v[148:151], v13 offset:32768
    ds_read_b64_tr_b16 v[52:53], v17 offset:49152
    ds_read_b64_tr_b16 v[54:55], v17 offset:49664
    v_mfma_f32_32x32x16_bf16 v[80:95], v[40:43], v[140:143], v[80:95]
    ds_read_b64_tr_b16 v[56:57], v17 offset:57344
    ds_read_b64_tr_b16 v[58:59], v17 offset:57856
    v_xor_b32 v13, 0x10000, v13
    v_xor_b32 v17, 65536, v17
    s_add_u32 m0, s9, 114688
    s_nop 0
    buffer_load_dwordx4 v10, s[44:47], s10 offen lds
    s_add_u32 m0, s9, 122880
    s_nop 0
    buffer_load_dwordx4 v10, s[48:51], s10 offen lds
    s_waitcnt lgkmcnt(5)
    v_mfma_f32_32x32x16_bf16 v[64:79], v[44:47], v[144:147], v[64:79]
    ds_read_b128 v[152:155], v14 offset:32768
    ds_read_b64_tr_b16 v[36:37], v18 offset:49152
    ds_read_b64_tr_b16 v[38:39], v18 offset:49664
    v_mfma_f32_32x32x16_bf16 v[80:95], v[48:51], v[144:147], v[80:95]
    ds_read_b64_tr_b16 v[40:41], v18 offset:57344
    ds_read_b64_tr_b16 v[42:43], v18 offset:57856
    v_xor_b32 v14, 0x10000, v14
    v_xor_b32 v18, 65536, v18
    s_add_u32 m0, s8, 0
    s_add_u32 s11, s76, 512
    s_and_b32 s11, s11, 0x3ff
    s_mul_i32 s10, s11, 1792
    buffer_load_dwordx4 v8, s[40:43], s11 offen lds
    s_waitcnt lgkmcnt(5)
    v_mfma_f32_32x32x16_bf16 v[64:79], v[52:55], v[148:151], v[64:79]
    ds_read_b128 v[156:159], v15 offset:32768
    ds_read_b64_tr_b16 v[44:45], v19 offset:49152
    ds_read_b64_tr_b16 v[46:47], v19 offset:49664
    v_mfma_f32_32x32x16_bf16 v[80:95], v[56:59], v[148:151], v[80:95]
    ds_read_b64_tr_b16 v[48:49], v19 offset:57344
    ds_read_b64_tr_b16 v[50:51], v19 offset:57856
    v_xor_b32 v15, 0x10000, v15
    v_xor_b32 v19, 65536, v19
    s_add_u32 m0, s8, 1024
    s_nop 0
    buffer_load_dwordx4 v9, s[40:43], s11 offen lds
    v_mfma_f32_4x4x4_16b_bf16 v[116:119], v[144:145], v[144:145], v[116:119]
    v_mfma_f32_4x4x4_16b_bf16 v[120:123], v[146:147], v[146:147], v[120:123]
    v_smfmac_f32_16x16x64_bf16 v[28:31], v[24:27], v[52:59], v32
    v_smfmac_f32_16x16x64_bf16 v[112:115], v[24:27], v[144:151], v32
    v_mfma_f32_4x4x4_16b_bf16 v[116:119], v[148:149], v[148:149], v[116:119]
    v_mfma_f32_4x4x4_16b_bf16 v[120:123], v[150:151], v[150:151], v[120:123]
    s_waitcnt vmcnt(6) lgkmcnt(0)
    s_barrier
    v_mfma_f32_32x32x16_bf16 v[64:79], v[36:39], v[152:155], v[64:79]
    ds_read_b128 v[160:163], v12 offset:0
    ds_read_b64_tr_b16 v[52:53], v16 offset:16384
    ds_read_b64_tr_b16 v[54:55], v16 offset:16896
    v_mfma_f32_32x32x16_bf16 v[80:95], v[40:43], v[152:155], v[80:95]
    ds_read_b64_tr_b16 v[56:57], v16 offset:24576
    ds_read_b64_tr_b16 v[58:59], v16 offset:25088
    s_add_u32 m0, s9, 16384
    s_nop 0
    buffer_load_dwordx4 v10, s[44:47], s10 offen lds
    s_waitcnt lgkmcnt(5)
    v_mfma_f32_32x32x16_bf16 v[64:79], v[44:47], v[156:159], v[64:79]
    ds_read_b128 v[164:167], v13 offset:0
    ds_read_b64_tr_b16 v[36:37], v17 offset:16384
    ds_read_b64_tr_b16 v[38:39], v17 offset:16896
    v_mfma_f32_32x32x16_bf16 v[80:95], v[48:51], v[156:159], v[80:95]
    ds_read_b64_tr_b16 v[40:41], v17 offset:24576
    ds_read_b64_tr_b16 v[42:43], v17 offset:25088
    s_add_u32 m0, s9, 24576
    s_nop 0
    buffer_load_dwordx4 v10, s[48:51], s10 offen lds
    s_waitcnt lgkmcnt(5)
    v_mfma_f32_32x32x16_bf16 v[64:79], v[52:55], v[160:163], v[64:79]
    ds_read_b128 v[168:171], v14 offset:0
    ds_read_b64_tr_b16 v[44:45], v18 offset:16384
    ds_read_b64_tr_b16 v[46:47], v18 offset:16896
    v_mfma_f32_32x32x16_bf16 v[80:95], v[56:59], v[160:163], v[80:95]
    ds_read_b64_tr_b16 v[48:49], v18 offset:24576
    ds_read_b64_tr_b16 v[50:51], v18 offset:25088
    s_add_u32 m0, s8, 32768
    s_add_u32 s11, s76, 640
    s_and_b32 s11, s11, 0x3ff
    s_mul_i32 s10, s11, 1792
    buffer_load_dwordx4 v8, s[40:43], s11 offen lds
    s_waitcnt lgkmcnt(5)
    v_mfma_f32_32x32x16_bf16 v[64:79], v[36:39], v[164:167], v[64:79]
    ds_read_b128 v[172:175], v15 offset:0
    ds_read_b64_tr_b16 v[52:53], v19 offset:16384
    ds_read_b64_tr_b16 v[54:55], v19 offset:16896
    v_mfma_f32_32x32x16_bf16 v[80:95], v[40:43], v[164:167], v[80:95]
    ds_read_b64_tr_b16 v[56:57], v19 offset:24576
    ds_read_b64_tr_b16 v[58:59], v19 offset:25088
    s_add_u32 m0, s8, 33792
    s_nop 0
    buffer_load_dwordx4 v9, s[40:43], s11 offen lds
    v_mfma_f32_4x4x4_16b_bf16 v[116:119], v[160:161], v[160:161], v[116:119]
    v_mfma_f32_4x4x4_16b_bf16 v[120:123], v[162:163], v[162:163], v[120:123]
    v_smfmac_f32_16x16x64_bf16 v[28:31], v[24:27], v[36:43], v32
    v_smfmac_f32_16x16x64_bf16 v[112:115], v[24:27], v[160:167], v32
    v_mfma_f32_4x4x4_16b_bf16 v[116:119], v[164:165], v[164:165], v[116:119]
    v_mfma_f32_4x4x4_16b_bf16 v[120:123], v[166:167], v[166:167], v[120:123]
    buffer_load_dword v60, v61, s[64:67], s83 offen
    s_add_u32 s83, s83, 1792
    s_cmp_eq_u32 s83, 14336
    s_cselect_b32 s83, 0, s83
    s_waitcnt vmcnt(7) lgkmcnt(0)
    s_barrier
    v_mfma_f32_32x32x16_bf16 v[64:79], v[44:47], v[168:171], v[64:79]
    ds_read_b128 v[176:179], v12 offset:32768
    ds_read_b64_tr_b16 v[36:37], v16 offset:49152
    ds_read_b64_tr_b16 v[38:39], v16 offset:49664
    v_mfma_f32_32x32x16_bf16 v[80:95], v[48:51], v[168:171], v[80:95]
    ds_read_b64_tr_b16 v[40:41], v16 offset:57344
    ds_read_b64_tr_b16 v[42:43], v16 offset:57856
    v_xor_b32 v12, 0x10000, v12
    v_xor_b32 v16, 65536, v16
    s_add_u32 m0, s9, 49152
    s_nop 0
    buffer_load_dwordx4 v10, s[44:47], s10 offen lds
    s_waitcnt lgkmcnt(5)
    v_mfma_f32_32x32x16_bf16 v[64:79], v[52:55], v[172:175], v[64:79]
    ds_read_b128 v[180:183], v13 offset:32768
    ds_read_b64_tr_b16 v[44:45], v17 offset:49152
    ds_read_b64_tr_b16 v[46:47], v17 offset:49664
    v_mfma_f32_32x32x16_bf16 v[80:95], v[56:59], v[172:175], v[80:95]
    ds_read_b64_tr_b16 v[48:49], v17 offset:57344
    ds_read_b64_tr_b16 v[50:51], v17 offset:57856
    v_xor_b32 v13, 0x10000, v13
    v_xor_b32 v17, 65536, v17
    s_add_u32 m0, s9, 57344
    s_nop 0
    buffer_load_dwordx4 v10, s[48:51], s10 offen lds
    s_waitcnt lgkmcnt(5)
    v_mfma_f32_32x32x16_bf16 v[64:79], v[36:39], v[176:179], v[64:79]
    ds_read_b128 v[184:187], v14 offset:32768
    ds_read_b64_tr_b16 v[52:53], v18 offset:49152
    ds_read_b64_tr_b16 v[54:55], v18 offset:49664
    v_mfma_f32_32x32x16_bf16 v[80:95], v[40:43], v[176:179], v[80:95]
    ds_read_b64_tr_b16 v[56:57], v18 offset:57344
    ds_read_b64_tr_b16 v[58:59], v18 offset:57856
    v_xor_b32 v14, 0x10000, v14
    v_xor_b32 v18, 65536, v18
    s_add_u32 m0, s8, 65536
    s_add_u32 s11, s76, 768
    s_and_b32 s11, s11, 0x3ff
    s_mul_i32 s10, s11, 1792
    buffer_load_dwordx4 v8, s[40:43], s11 offen lds
    buffer_load_dword v60, v61, s[64:67], s83 offen
    s_add_u32 s83, s83, 1792
    s_cmp_eq_u32 s83, 14336
    s_cselect_b32 s83, 0, s83
    s_waitcnt lgkmcnt(5)
    v_mfma_f32_32x32x16_bf16 v[64:79], v[44:47], v[180:183], v[64:79]
    ds_read_b128 v[188:191], v15 offset:32768
    ds_read_b64_tr_b16 v[36:37], v19 offset:49152
    ds_read_b64_tr_b16 v[38:39], v19 offset:49664
    v_mfma_f32_32x32x16_bf16 v[80:95], v[48:51], v[180:183], v[80:95]
    ds_read_b64_tr_b16 v[40:41], v19 offset:57344
    ds_read_b64_tr_b16 v[42:43], v19 offset:57856
    v_xor_b32 v15, 0x10000, v15
    v_xor_b32 v19, 65536, v19
    s_add_u32 m0, s8, 66560
    s_nop 0
    buffer_load_dwordx4 v9, s[40:43], s11 offen lds
    v_mfma_f32_4x4x4_16b_bf16 v[116:119], v[176:177], v[176:177], v[116:119]
    v_mfma_f32_4x4x4_16b_bf16 v[120:123], v[178:179], v[178:179], v[120:123]
    v_smfmac_f32_16x16x64_bf16 v[28:31], v[24:27], v[44:51], v32
    v_smfmac_f32_16x16x64_bf16 v[112:115], v[24:27], v[176:183], v32
    v_mfma_f32_4x4x4_16b_bf16 v[116:119], v[180:181], v[180:181], v[116:119]
    v_mfma_f32_4x4x4_16b_bf16 v[120:123], v[182:183], v[182:183], v[120:123]
    buffer_load_dword v60, v127, s[40:43], 0 offen
    buffer_load_dword v60, v126, s[56:59], 0 offen
    buffer_load_dword v60, v126, s[60:63], 0 offen
    s_waitcnt vmcnt(11) lgkmcnt(0)
    s_barrier
    v_mfma_f32_32x32x16_bf16 v[64:79], v[52:55], v[184:187], v[64:79]
    ds_read_b128 v[192:195], v12 offset:0
    ds_read_b64_tr_b16 v[44:45], v16 offset:16384
    ds_read_b64_tr_b16 v[46:47], v16 offset:16896
    v_mfma_f32_32x32x16_bf16 v[80:95], v[56:59], v[184:187], v[80:95]
    ds_read_b64_tr_b16 v[48:49], v16 offset:24576
    ds_read_b64_tr_b16 v[50:51], v16 offset:25088
    s_add_u32 m0, s9, 81920
    s_nop 0
    buffer_load_dwordx4 v10, s[44:47], s10 offen lds
    s_waitcnt lgkmcnt(5)
    v_mfma_f32_32x32x16_bf16 v[64:79], v[36:39], v[188:191], v[64:79]
    ds_read_b128 v[196:199], v13 offset:0
    ds_read_b64_tr_b16 v[52:53], v17 offset:16384
    ds_read_b64_tr_b16 v[54:55], v17 offset:16896
    v_mfma_f32_32x32x16_bf16 v[80:95], v[40:43], v[188:191], v[80:95]
    ds_read_b64_tr_b16 v[56:57], v17 offset:24576
    ds_read_b64_tr_b16 v[58:59], v17 offset:25088
    s_add_u32 m0, s9, 90112
    s_nop 0
    buffer_load_dwordx4 v10, s[48:51], s10 offen lds
    buffer_load_dword v60, v61, s[64:67], s83 offen
    s_add_u32 s83, s83, 1792
    s_cmp_eq_u32 s83, 14336
    s_cselect_b32 s83, 0, s83
    s_waitcnt lgkmcnt(5)
    v_mfma_f32_32x32x16_bf16 v[64:79], v[44:47], v[192:195], v[64:79]
    ds_read_b128 v[200:203], v14 offset:0
    ds_read_b64_tr_b16 v[36:37], v18 offset:16384
    ds_read_b64_tr_b16 v[38:39], v18 offset:16896
    v_mfma_f32_32x32x16_bf16 v[80:95], v[48:51], v[192:195], v[80:95]
    ds_read_b64_tr_b16 v[40:41], v18 offset:24576
    ds_read_b64_tr_b16 v[42:43], v18 offset:25088
    s_add_u32 m0, s8, 98304
    s_add_u32 s11, s76, 896
    s_and_b32 s11, s11, 0x3ff
    s_mul_i32 s10, s11, 1792
    buffer_load_dwordx4 v8, s[40:43], s11 offen lds
    s_waitcnt lgkmcnt(5)
    v_mfma_f32_32x32x16_bf16 v[64:79], v[52:55], v[196:199], v[64:79]
    ds_read_b128 v[204:207], v15 offset:0
    ds_read_b64_tr_b16 v[44:45], v19 offset:16384
    ds_read_b64_tr_b16 v[46:47], v19 offset:16896
    v_mfma_f32_32x32x16_bf16 v[80:95], v[56:59], v[196:199], v[80:95]
    ds_read_b64_tr_b16 v[48:49], v19 offset:24576
    ds_read_b64_tr_b16 v[50:51], v19 offset:25088
    s_add_u32 m0, s8, 99328
    s_nop 0
    buffer_load_dwordx4 v9, s[40:43], s11 offen lds
    v_mfma_f32_4x4x4_16b_bf16 v[116:119], v[192:193], v[192:193], v[116:119]
    v_mfma_f32_4x4x4_16b_bf16 v[120:123], v[194:195], v[194:195], v[120:123]
    v_smfmac_f32_16x16x64_bf16 v[28:31], v[24:27], v[52:59], v32
    v_smfmac_f32_16x16x64_bf16 v[112:115], v[24:27], v[192:199], v32
    v_mfma_f32_4x4x4_16b_bf16 v[116:119], v[196:197], v[196:197], v[116:119]
    v_mfma_f32_4x4x4_16b_bf16 v[120:123], v[198:199], v[198:199], v[120:123]
    s_waitcnt vmcnt(11) lgkmcnt(0)
    s_barrier
    v_mfma_f32_32x32x16_bf16 v[64:79], v[36:39], v[200:203], v[64:79]
    ds_read_b128 v[208:211], v12 offset:32768
    ds_read_b64_tr_b16 v[52:53], v16 offset:49152
    ds_read_b64_tr_b16 v[54:55], v16 offset:49664
    v_mfma_f32_32x32x16_bf16 v[80:95], v[40:43], v[200:203], v[80:95]
    ds_read_b64_tr_b16 v[56:57], v16 offset:57344
    ds_read_b64_tr_b16 v[58:59], v16 offset:57856
    v_xor_b32 v12, 0x10000, v12
    v_xor_b32 v16, 65536, v16
    s_add_u32 m0, s9, 114688
    s_nop 0
    buffer_load_dwordx4 v10, s[44:47], s10 offen lds
    buffer_load_dword v60, v61, s[64:67], s83 offen
    s_add_u32 s83, s83, 1792
    s_cmp_eq_u32 s83, 14336
    s_cselect_b32 s83, 0, s83
    s_waitcnt lgkmcnt(5)
    v_mfma_f32_32x32x16_bf16 v[64:79], v[44:47], v[204:207], v[64:79]
    ds_read_b128 v[212:215], v13 offset:32768
    ds_read_b64_tr_b16 v[36:37], v17 offset:49152
    ds_read_b64_tr_b16 v[38:39], v17 offset:49664
    v_mfma_f32_32x32x16_bf16 v[80:95], v[48:51], v[204:207], v[80:95]
    ds_read_b64_tr_b16 v[40:41], v17 offset:57344
    ds_read_b64_tr_b16 v[42:43], v17 offset:57856
    v_xor_b32 v13, 0x10000, v13
    v_xor_b32 v17, 65536, v17
    s_add_u32 m0, s9, 122880
    s_nop 0
    buffer_load_dwordx4 v10, s[48:51], s10 offen lds
    s_waitcnt lgkmcnt(5)
    v_mfma_f32_32x32x16_bf16 v[64:79], v[52:55], v[208:211], v[64:79]
    ds_read_b128 v[216:219], v14 offset:32768
    ds_read_b64_tr_b16 v[44:45], v18 offset:49152
    ds_read_b64_tr_b16 v[46:47], v18 offset:49664
    v_mfma_f32_32x32x16_bf16 v[80:95], v[56:59], v[208:211], v[80:95]
    ds_read_b64_tr_b16 v[48:49], v18 offset:57344
    ds_read_b64_tr_b16 v[50:51], v18 offset:57856
    v_xor_b32 v14, 0x10000, v14
    v_xor_b32 v18, 65536, v18
    s_add_u32 m0, s9, 131072
    s_add_u32 s11, s76, 0
    s_and_b32 s11, s11, 0x3ff
    s_mul_i32 s10, s11, 1792
    s_add_u32 s10, s10, 128
    buffer_load_dwordx4 v10, s[44:47], s10 offen lds
    s_waitcnt lgkmcnt(5)
    v_mfma_f32_32x32x16_bf16 v[64:79], v[36:39], v[212:215], v[64:79]
    ds_read_b128 v[220:223], v15 offset:32768
    ds_read_b64_tr_b16 v[52:53], v19 offset:49152
    ds_read_b64_tr_b16 v[54:55], v19 offset:49664
    v_mfma_f32_32x32x16_bf16 v[80:95], v[40:43], v[212:215], v[80:95]
    ds_read_b64_tr_b16 v[56:57], v19 offset:57344
    ds_read_b64_tr_b16 v[58:59], v19 offset:57856
    v_xor_b32 v15, 0x10000, v15
    v_xor_b32 v19, 65536, v19
    s_add_u32 m0, s9, 139264
    s_nop 0
    buffer_load_dwordx4 v10, s[48:51], s10 offen lds
    v_mfma_f32_4x4x4_16b_bf16 v[116:119], v[208:209], v[208:209], v[116:119]
    v_mfma_f32_4x4x4_16b_bf16 v[120:123], v[210:211], v[210:211], v[120:123]
    v_smfmac_f32_16x16x64_bf16 v[28:31], v[24:27], v[36:43], v32
    v_smfmac_f32_16x16x64_bf16 v[112:115], v[24:27], v[208:215], v32
    v_mfma_f32_4x4x4_16b_bf16 v[116:119], v[212:213], v[212:213], v[116:119]
    v_mfma_f32_4x4x4_16b_bf16 v[120:123], v[214:215], v[214:215], v[120:123]
    buffer_load_dword v60, v61, s[64:67], s83 offen
    s_add_u32 s83, s83, 1792
    s_cmp_eq_u32 s83, 14336
    s_cselect_b32 s83, 0, s83
    s_waitcnt vmcnt(9) lgkmcnt(0)
    s_barrier
    v_mfma_f32_32x32x16_bf16 v[64:79], v[44:47], v[216:219], v[64:79]
    ds_read_b128 v[224:227], v12 offset:0
    ds_read_b64_tr_b16 v[36:37], v16 offset:16384
    ds_read_b64_tr_b16 v[38:39], v16 offset:16896
    v_mfma_f32_32x32x16_bf16 v[80:95], v[48:51], v[216:219], v[80:95]
    ds_read_b64_tr_b16 v[40:41], v16 offset:24576
    ds_read_b64_tr_b16 v[42:43], v16 offset:25088
    s_add_u32 m0, s9, 147456
    s_add_u32 s11, s76, 128
    s_and_b32 s11, s11, 0x3ff
    s_mul_i32 s10, s11, 1792
    s_add_u32 s10, s10, 128
    buffer_load_dwordx4 v10, s[44:47], s10 offen lds
    s_waitcnt lgkmcnt(5)
    v_mfma_f32_32x32x16_bf16 v[64:79], v[52:55], v[220:223], v[64:79]
    ds_read_b128 v[228:231], v13 offset:0
    ds_read_b64_tr_b16 v[44:45], v17 offset:16384
    ds_read_b64_tr_b16 v[46:47], v17 offset:16896
    v_mfma_f32_32x32x16_bf16 v[80:95], v[56:59], v[220:223], v[80:95]
    ds_read_b64_tr_b16 v[48:49], v17 offset:24576
    ds_read_b64_tr_b16 v[50:51], v17 offset:25088
    s_add_u32 m0, s9, 155648
    s_nop 0
    buffer_load_dwordx4 v10, s[48:51], s10 offen lds
    s_waitcnt lgkmcnt(5)
    v_mfma_f32_32x32x16_bf16 v[64:79], v[36:39], v[224:227], v[64:79]
    ds_read_b128 v[232:235], v14 offset:0
    ds_read_b64_tr_b16 v[52:53], v18 offset:16384
    ds_read_b64_tr_b16 v[54:55], v18 offset:16896
    v_mfma_f32_32x32x16_bf16 v[80:95], v[40:43], v[224:227], v[80:95]
    ds_read_b64_tr_b16 v[56:57], v18 offset:24576
    ds_read_b64_tr_b16 v[58:59], v18 offset:25088
    s_add_u32 m0, s9, 0
    s_add_u32 s11, s76, 256
    s_and_b32 s11, s11, 0x3ff
    s_mul_i32 s10, s11, 1792
    s_add_u32 s10, s10, 128
    buffer_load_dwordx4 v10, s[44:47], s10 offen lds
    buffer_load_dword v60, v61, s[64:67], s83 offen
    s_add_u32 s83, s83, 1792
    s_cmp_eq_u32 s83, 14336
    s_cselect_b32 s83, 0, s83
    s_waitcnt lgkmcnt(5)
    v_mfma_f32_32x32x16_bf16 v[64:79], v[44:47], v[228:231], v[64:79]
    ds_read_b128 v[236:239], v15 offset:0
    ds_read_b64_tr_b16 v[36:37], v19 offset:16384
    ds_read_b64_tr_b16 v[38:39], v19 offset:16896
    v_mfma_f32_32x32x16_bf16 v[80:95], v[48:51], v[228:231], v[80:95]
    ds_read_b64_tr_b16 v[40:41], v19 offset:24576
    ds_read_b64_tr_b16 v[42:43], v19 offset:25088
    s_add_u32 m0, s9, 8192
    s_nop 0
    buffer_load_dwordx4 v10, s[48:51], s10 offen lds
    v_mfma_f32_4x4x4_16b_bf16 v[116:119], v[224:225], v[224:225], v[116:119]
    v_mfma_f32_4x4x4_16b_bf16 v[120:123], v[226:227], v[226:227], v[120:123]
    v_smfmac_f32_16x16x64_bf16 v[28:31], v[24:27], v[44:51], v32
    v_smfmac_f32_16x16x64_bf16 v[112:115], v[24:27], v[224:231], v32
    v_mfma_f32_4x4x4_16b_bf16 v[116:119], v[228:229], v[228:229], v[116:119]
    v_mfma_f32_4x4x4_16b_bf16 v[120:123], v[230:231], v[230:231], v[120:123]
    s_waitcnt vmcnt(8) lgkmcnt(0)
    s_barrier
    v_mfma_f32_32x32x16_bf16 v[64:79], v[52:55], v[232:235], v[64:79]
    ds_read_b128 v[240:243], v12 offset:32768
    ds_read_b64_tr_b16 v[44:45], v16 offset:49152
    ds_read_b64_tr_b16 v[46:47], v16 offset:49664
    v_mfma_f32_32x32x16_bf16 v[80:95], v[56:59], v[232:235], v[80:95]
    ds_read_b64_tr_b16 v[48:49], v16 offset:57344
    ds_read_b64_tr_b16 v[50:51], v16 offset:57856
    v_xor_b32 v16, 196608, v16
    s_add_u32 m0, s9, 16384
    s_add_u32 s11, s76, 384
    s_and_b32 s11, s11, 0x3ff
    s_mul_i32 s10, s11, 1792
    s_add_u32 s10, s10, 128
    buffer_load_dwordx4 v10, s[44:47], s10 offen lds
    s_waitcnt lgkmcnt(5)
    v_mfma_f32_32x32x16_bf16 v[64:79], v[36:39], v[236:239], v[64:79]
    ds_read_b128 v[244:247], v13 offset:32768
    ds_read_b64_tr_b16 v[52:53], v17 offset:49152
    ds_read_b64_tr_b16 v[54:55], v17 offset:49664
    v_mfma_f32_32x32x16_bf16 v[80:95], v[40:43], v[236:239], v[80:95]
    ds_read_b64_tr_b16 v[56:57], v17 offset:57344
    ds_read_b64_tr_b16 v[58:59], v17 offset:57856
    v_xor_b32 v17, 196608, v17
    s_add_u32 m0, s9, 24576
    s_nop 0
    buffer_load_dwordx4 v10, s[48:51], s10 offen lds
    buffer_load_dword v60, v61, s[64:67], s83 offen
    s_add_u32 s83, s83, 1792
    s_cmp_eq_u32 s83, 14336
    s_cselect_b32 s83, 0, s83
    s_waitcnt lgkmcnt(5)
    v_mfma_f32_32x32x16_bf16 v[64:79], v[44:47], v[240:243], v[64:79]
    ds_read_b128 v[248:251], v14 offset:32768
    ds_read_b64_tr_b16 v[36:37], v18 offset:49152
    ds_read_b64_tr_b16 v[38:39], v18 offset:49664
    v_mfma_f32_32x32x16_bf16 v[80:95], v[48:51], v[240:243], v[80:95]
    ds_read_b64_tr_b16 v[40:41], v18 offset:57344
    ds_read_b64_tr_b16 v[42:43], v18 offset:57856
    v_xor_b32 v18, 196608, v18
    s_add_u32 m0, s9, 32768
    s_add_u32 s11, s76, 512
    s_and_b32 s11, s11, 0x3ff
    s_mul_i32 s10, s11, 1792
    s_add_u32 s10, s10, 128
    buffer_load_dwordx4 v10, s[44:47], s10 offen lds
    s_waitcnt lgkmcnt(5)
    v_mfma_f32_32x32x16_bf16 v[64:79], v[52:55], v[244:247], v[64:79]
    ds_read_b128 v[252:255], v15 offset:32768
    ds_read_b64_tr_b16 v[44:45], v19 offset:49152
    ds_read_b64_tr_b16 v[46:47], v19 offset:49664
    v_mfma_f32_32x32x16_bf16 v[80:95], v[56:59], v[244:247], v[80:95]
    ds_read_b64_tr_b16 v[48:49], v19 offset:57344
    ds_read_b64_tr_b16 v[50:51], v19 offset:57856
    v_xor_b32 v19, 196608, v19
    s_add_u32 m0, s9, 40960
    s_nop 0
    buffer_load_dwordx4 v10, s[48:51], s10 offen lds
    v_mfma_f32_4x4x4_16b_bf16 v[116:119], v[240:241], v[240:241], v[116:119]
    v_mfma_f32_4x4x4_16b_bf16 v[120:123], v[242:243], v[242:243], v[120:123]
    v_smfmac_f32_16x16x64_bf16 v[28:31], v[24:27], v[52:59], v32
    v_smfmac_f32_16x16x64_bf16 v[112:115], v[24:27], v[240:247], v32
    v_mfma_f32_4x4x4_16b_bf16 v[116:119], v[244:245], v[244:245], v[116:119]
    v_mfma_f32_4x4x4_16b_bf16 v[120:123], v[246:247], v[246:247], v[120:123]
    s_nop 9
    v_add_f32 v112, v112, v113
    v_add_f32 v114, v114, v115
    v_add_f32 v112, v112, v114
    v_add_f32 v116, v116, v120
    v_add_f32 v117, v117, v121
    v_add_f32 v118, v118, v122
    v_add_f32 v119, v119, v123
    s_mov_b32 vcc_lo, 0xaaaaaaaa
    s_mov_b32 vcc_hi, 0xaaaaaaaa
    v_cndmask_b32 v21, v116, v117, vcc
    v_cndmask_b32 v22, v118, v119, vcc
    s_mov_b32 vcc_lo, 0xcccccccc
    s_mov_b32 vcc_hi, 0xcccccccc
    v_cndmask_b32 v21, v21, v22, vcc
    v_add_f32 v21, v21, v23
    v_mov_b32 v23, v21
    v_add_f32 v34, v28, v29
    v_add_f32 v35, v30, v31
    v_add_u32 v3, 61440, v62
    ds_write_b64 v3, v[34:35]
    v_mov_b32 v28, 0
    v_mov_b32 v29, 0
    v_mov_b32 v30, 0
    v_mov_b32 v31, 0
    v_permlane32_swap_b32 v21, v23
    v_mov_b32 v20, v112
    v_add_f32 v21, v21, v23
    ds_write_b64 v62, v[20:21] offset:57344
    v_xor_b32 v2, 512, v62
    s_waitcnt vmcnt(11) lgkmcnt(0)
    s_barrier
    ds_read_b64 v[22:23], v2 offset:57344
    v_add_u32 v3, 61440, v63
    ds_read2_b64 v[108:111], v3 offset0:0 offset1:128
    v_mfma_f32_32x32x16_bf16 v[64:79], v[36:39], v[248:251], v[64:79]
    ds_read_b64_tr_b16 v[52:53], v16 offset:0
    ds_read_b64_tr_b16 v[54:55], v16 offset:512
    v_mfma_f32_32x32x16_bf16 v[80:95], v[40:43], v[248:251], v[80:95]
    ds_read_b64_tr_b16 v[56:57], v16 offset:8192
    ds_read_b64_tr_b16 v[58:59], v16 offset:8704
    s_add_u32 m0, s9, 65536
    s_add_u32 s11, s76, 640
    s_and_b32 s11, s11, 0x3ff
    s_mul_i32 s10, s11, 1792
    s_add_u32 s10, s10, 128
    buffer_load_dwordx4 v10, s[44:47], s10 offen lds
    buffer_load_dword v60, v61, s[64:67], s83 offen
    s_add_u32 s83, s83, 1792
    s_cmp_eq_u32 s83, 14336
    s_cselect_b32 s83, 0, s83
    s_waitcnt lgkmcnt(8)
    v_mfma_f32_32x32x16_bf16 v[64:79], v[44:47], v[252:255], v[64:79]
    ds_read_b64_tr_b16 v[36:37], v17 offset:0
    ds_read_b64_tr_b16 v[38:39], v17 offset:512
    s_waitcnt lgkmcnt(6)
    v_add_f32 v20, v20, v22
    v_add_f32 v21, v21, v23
    v_mul_f32 v4, 0x3b000000, v20
    v_mul_f32 v5, 0x3b000000, v21
    v_cvt_pk_bf16_f32 v20, -v4, -v4
    v_fma_f32 v5, -v4, v4, v5
    v_mov_b32 v96, v20
    v_add_f32 v108, v108, v110
    v_mfma_f32_32x32x16_bf16 v[80:95], v[48:51], v[252:255], v[80:95]
    ds_read_b64_tr_b16 v[40:41], v17 offset:8192
    ds_read_b64_tr_b16 v[42:43], v17 offset:8704
    s_add_u32 m0, s9, 73728
    s_nop 0
    buffer_load_dwordx4 v10, s[48:51], s10 offen lds
    v_add_f32 v109, v109, v111
    v_cvt_pk_bf16_f32 v110, v108, v108
    v_cvt_pk_bf16_f32 v111, v109, v109
    v_lshlrev_b32 v110, 16, v110
    v_lshlrev_b32 v111, 16, v111
    v_sub_f32 v108, v108, v110
    v_sub_f32 v109, v109, v111
    v_cvt_pk_bf16_f32 v100, v110, v108
    v_cvt_pk_bf16_f32 v104, v111, v109
    s_nop 0
    v_mfma_f32_32x32x16_bf16 v[64:79], v[100:103], v[96:99], v[64:79]
    v_mfma_f32_32x32x16_bf16 v[80:95], v[104:107], v[96:99], v[80:95]
    s_waitcnt lgkmcnt(4)
    v_mfma_f32_32x32x16_bf16 v[96:111], v[52:55], v[128:131], 0
    ds_read_b64_tr_b16 v[44:45], v18 offset:0
    ds_read_b64_tr_b16 v[46:47], v18 offset:512
    v_max_f32 v5, 0, v5
    v_cvt_pk_bf16_f32 v5, v5, v5
    v_lshlrev_b32 v5, 16, v5
    v_add_f32 v5, 0x3727c5ac, v5
    v_cvt_pk_bf16_f32 v5, v5, v5
    v_lshlrev_b32 v5, 16, v5
    v_sqrt_f32 v5, v5
    s_nop 0
    v_cvt_pk_bf16_f32 v5, v5, v5
    v_mfma_f32_32x32x16_bf16 v[112:127], v[56:59], v[128:131], 0
    ds_read_b64_tr_b16 v[48:49], v18 offset:8192
    ds_read_b64_tr_b16 v[50:51], v18 offset:8704
    s_add_u32 m0, s9, 81920
    s_add_u32 s11, s76, 768
    s_and_b32 s11, s11, 0x3ff
    s_mul_i32 s10, s11, 1792
    s_add_u32 s10, s10, 128
    buffer_load_dwordx4 v10, s[44:47], s10 offen lds
    v_lshlrev_b32 v5, 16, v5
    v_rcp_f32 v4, v5
    v_mul_f32 v23, v5, v5
    v_mul_f32 v21, 0xc0135761, v4
    v_mul_f32 v22, v4, v4
    v_mul_f32 v22, v22, v4
    v_mul_f32 v22, 0xbdd2d3e8, v22
    v_lshlrev_b32 v8, 4, v1
    s_waitcnt lgkmcnt(4)
    v_mfma_f32_32x32x16_bf16 v[96:111], v[36:39], v[132:135], v[96:111]
    ds_read_b64_tr_b16 v[52:53], v19 offset:0
    ds_read_b64_tr_b16 v[54:55], v19 offset:512
    v_mul_f32 v4, v64, v64
    v_mul_f32 v5, v65, v65
    v_mul_f32 v6, v66, v66
    v_mul_f32 v7, v67, v67
    v_fma_f32 v4, v4, v22, v21
    v_fma_f32 v5, v5, v22, v21
    v_mfma_f32_32x32x16_bf16 v[112:127], v[40:43], v[132:135], v[112:127]
    ds_read_b64_tr_b16 v[56:57], v19 offset:8192
    ds_read_b64_tr_b16 v[58:59], v19 offset:8704
    s_add_u32 m0, s9, 90112
    s_nop 0
    buffer_load_dwordx4 v10, s[48:51], s10 offen lds
    v_fma_f32 v6, v6, v22, v21
    v_fma_f32 v7, v7, v22, v21
    v_mul_f32 v4, v4, v64
    v_mul_f32 v5, v5, v65
    v_mul_f32 v6, v6, v66
    v_smfmac_f32_16x16x64_bf16 v[28:31], v[24:27], v[36:43], v32
    s_waitcnt vmcnt(13) lgkmcnt(0)
    s_barrier
    v_mfma_f32_32x32x16_bf16 v[96:111], v[44:47], v[136:139], v[96:111]
    ds_read_b64_tr_b16 v[36:37], v16 offset:16384
    ds_read_b64_tr_b16 v[38:39], v16 offset:16896
    ds_read_b64_tr_b16 v[40:41], v16 offset:24576
    v_mul_f32 v7, v7, v67
    v_exp_f32 v4, v4
    v_mul_f32 v12, v64, v80
    v_exp_f32 v5, v5
    v_mul_f32 v13, v65, v81
    v_exp_f32 v6, v6
    v_mfma_f32_32x32x16_bf16 v[112:127], v[48:51], v[136:139], v[112:127]
    ds_read_b64_tr_b16 v[42:43], v16 offset:25088
    v_xor_b32 v16, 131072, v16
    s_add_u32 m0, s9, 98304
    s_add_u32 s11, s76, 896
    s_and_b32 s11, s11, 0x3ff
    s_mul_i32 s10, s11, 1792
    s_add_u32 s10, s10, 128
    buffer_load_dwordx4 v10, s[44:47], s10 offen lds
    v_mul_f32 v14, v66, v82
    v_exp_f32 v7, v7
    v_mul_f32 v15, v67, v83
    v_fma_f32 v4, v4, v23, v23
    v_fma_f32 v5, v5, v23, v23
    v_fma_f32 v6, v6, v23, v23
    s_waitcnt lgkmcnt(4)
    v_mfma_f32_32x32x16_bf16 v[96:111], v[52:55], v[140:143], v[96:111]
    ds_read_b64_tr_b16 v[44:45], v17 offset:16384
    ds_read_b64_tr_b16 v[46:47], v17 offset:16896
    ds_read_b64_tr_b16 v[48:49], v17 offset:24576
    v_fma_f32 v7, v7, v23, v23
    v_rcp_f32 v4, v4
    v_rcp_f32 v5, v5
    v_rcp_f32 v6, v6
    v_rcp_f32 v7, v7
    v_mul_f32 v12, v12, v4
    v_mfma_f32_32x32x16_bf16 v[112:127], v[56:59], v[140:143], v[112:127]
    ds_read_b64_tr_b16 v[50:51], v17 offset:25088
    v_xor_b32 v17, 131072, v17
    s_add_u32 m0, s9, 106496
    s_nop 0
    buffer_load_dwordx4 v10, s[48:51], s10 offen lds
    v_mul_f32 v13, v13, v5
    v_mul_f32 v14, v14, v6
    v_mul_f32 v15, v15, v7
    v_cvt_pk_bf16_f32 v128, v12, v13
    v_cvt_pk_bf16_f32 v129, v14, v15
    s_waitcnt lgkmcnt(4)
    v_mfma_f32_32x32x16_bf16 v[96:111], v[36:39], v[144:147], v[96:111]
    ds_read_b64_tr_b16 v[52:53], v18 offset:16384
    ds_read_b64_tr_b16 v[54:55], v18 offset:16896
    ds_read_b64_tr_b16 v[56:57], v18 offset:24576
    v_mul_f32 v4, v68, v68
    v_mul_f32 v5, v69, v69
    v_mul_f32 v6, v70, v70
    v_mul_f32 v7, v71, v71
    v_fma_f32 v4, v4, v22, v21
    v_fma_f32 v5, v5, v22, v21
    v_mfma_f32_32x32x16_bf16 v[112:127], v[40:43], v[144:147], v[112:127]
    ds_read_b64_tr_b16 v[58:59], v18 offset:25088
    v_xor_b32 v18, 131072, v18
    s_add_u32 m0, s80, 49152
    s_add_u32 s12, s16, 0
    buffer_load_dwordx4 v11, s[64:67], s12 offen lds
    v_fma_f32 v6, v6, v22, v21
    v_fma_f32 v7, v7, v22, v21
    v_mul_f32 v4, v4, v68
    v_mul_f32 v5, v5, v69
    v_mul_f32 v6, v6, v70
    v_mul_f32 v7, v7, v71
    s_waitcnt lgkmcnt(4)
    v_mfma_f32_32x32x16_bf16 v[96:111], v[44:47], v[148:151], v[96:111]
    ds_read_b64_tr_b16 v[36:37], v19 offset:16384
    ds_read_b64_tr_b16 v[38:39], v19 offset:16896
    ds_read_b64_tr_b16 v[40:41], v19 offset:24576
    v_exp_f32 v4, v4
    v_mul_f32 v12, v68, v84
    v_exp_f32 v5, v5
    v_mul_f32 v13, v69, v85
    v_exp_f32 v6, v6
    v_mul_f32 v14, v70, v86
    v_mfma_f32_32x32x16_bf16 v[112:127], v[48:51], v[148:151], v[112:127]
    ds_read_b64_tr_b16 v[42:43], v19 offset:25088
    v_xor_b32 v19, 131072, v19
    s_add_u32 m0, s80, 57344
    s_add_u32 s12, s16, 16384
    buffer_load_dwordx4 v11, s[64:67], s12 offen lds
    v_exp_f32 v7, v7
    v_mul_f32 v15, v71, v87
    v_fma_f32 v4, v4, v23, v23
    v_fma_f32 v5, v5, v23, v23
    v_fma_f32 v6, v6, v23, v23
    v_smfmac_f32_16x16x64_bf16 v[28:31], v[24:27], v[44:51], v32
    s_waitcnt vmcnt(14) lgkmcnt(0)
    s_barrier
    v_mfma_f32_32x32x16_bf16 v[96:111], v[52:55], v[152:155], v[96:111]
    ds_read_b64_tr_b16 v[44:45], v16 offset:0
    ds_read_b64_tr_b16 v[46:47], v16 offset:512
    v_fma_f32 v7, v7, v23, v23
    v_rcp_f32 v4, v4
    v_rcp_f32 v5, v5
    v_rcp_f32 v6, v6
    v_rcp_f32 v7, v7
    v_mul_f32 v12, v12, v4
    v_mfma_f32_32x32x16_bf16 v[112:127], v[56:59], v[152:155], v[112:127]
    ds_read_b64_tr_b16 v[48:49], v16 offset:8192
    ds_read_b64_tr_b16 v[50:51], v16 offset:8704
    s_add_u32 m0, s80, 114688
    s_add_u32 s12, s17, 0
    buffer_load_dwordx4 v11, s[64:67], s12 offen lds
    v_mul_f32 v13, v13, v5
    v_mul_f32 v14, v14, v6
    v_mul_f32 v15, v15, v7
    v_cvt_pk_bf16_f32 v130, v12, v13
    v_cvt_pk_bf16_f32 v131, v14, v15
    buffer_store_dwordx4 v[128:131], v8, s[52:55], s29 offen offset:0 sc1
    s_waitcnt lgkmcnt(4)
    v_mfma_f32_32x32x16_bf16 v[96:111], v[36:39], v[156:159], v[96:111]
    ds_read_b64_tr_b16 v[52:53], v17 offset:0
    ds_read_b64_tr_b16 v[54:55], v17 offset:512
    v_mul_f32 v4, v72, v72
    v_mul_f32 v5, v73, v73
    v_mul_f32 v6, v74, v74
    v_mul_f32 v7, v75, v75
    v_fma_f32 v4, v4, v22, v21
    v_fma_f32 v5, v5, v22, v21
    v_mfma_f32_32x32x16_bf16 v[112:127], v[40:43], v[156:159], v[112:127]
    ds_read_b64_tr_b16 v[56:57], v17 offset:8192
    ds_read_b64_tr_b16 v[58:59], v17 offset:8704
    s_add_u32 m0, s80, 122880
    s_add_u32 s12, s17, 16384
    buffer_load_dwordx4 v11, s[64:67], s12 offen lds
    v_fma_f32 v6, v6, v22, v21
    v_fma_f32 v7, v7, v22, v21
    v_mul_f32 v4, v4, v72
    v_mul_f32 v5, v5, v73
    v_mul_f32 v6, v6, v74
    s_waitcnt lgkmcnt(4)
    v_mfma_f32_32x32x16_bf16 v[96:111], v[44:47], v[160:163], v[96:111]
    ds_read_b64_tr_b16 v[36:37], v18 offset:0
    ds_read_b64_tr_b16 v[38:39], v18 offset:512
    v_mul_f32 v7, v7, v75
    v_exp_f32 v4, v4
    v_mul_f32 v12, v72, v88
    v_exp_f32 v5, v5
    v_mul_f32 v13, v73, v89
    v_exp_f32 v6, v6
    v_mul_f32 v14, v74, v90
    v_exp_f32 v7, v7
    v_mul_f32 v15, v75, v91
    v_fma_f32 v4, v4, v23, v23
    v_fma_f32 v5, v5, v23, v23
    v_fma_f32 v6, v6, v23, v23
    v_bfe_u32 v2, v1, 2, 2
    v_bfe_u32 v3, v1, 5, 1
    v_lshl_add_u32 v2, v3, 2, v2
    v_mfma_f32_32x32x16_bf16 v[112:127], v[48:51], v[160:163], v[112:127]
    ds_read_b64_tr_b16 v[40:41], v18 offset:8192
    ds_read_b64_tr_b16 v[42:43], v18 offset:8704
    s_add_u32 m0, s80, 131072
    s_add_u32 s12, s18, 0
    buffer_load_dwordx4 v11, s[64:67], s12 offen lds
    v_lshlrev_b32 v148, 7, v2
    v_bfe_u32 v2, v1, 3, 1
    v_bfe_u32 v3, v1, 4, 1
    v_lshl_or_b32 v2, v2, 1, v3
    v_xor_b32 v2, s5, v2
    v_lshl_add_u32 v148, v2, 5, v148
    v_and_b32 v2, 3, v1
    v_lshl_add_u32 v148, v2, 3, v148
    s_lshl_b32 s15, s5, 11
    v_add_u32 v148, s15, v148
    v_xor_b32 v149, 64, v148
    v_add_u32 v150, 65536, v148
    v_add_u32 v151, 65536, v149
    v_add_u32 v152, 131072, v148
    v_add_u32 v153, 131072, v149
    s_waitcnt lgkmcnt(4)
    v_mfma_f32_32x32x16_bf16 v[96:111], v[52:55], v[164:167], v[96:111]
    ds_read_b64_tr_b16 v[44:45], v19 offset:0
    ds_read_b64_tr_b16 v[46:47], v19 offset:512
    v_fma_f32 v7, v7, v23, v23
    v_rcp_f32 v4, v4
    v_rcp_f32 v5, v5
    v_rcp_f32 v6, v6
    v_rcp_f32 v7, v7
    v_mul_f32 v12, v12, v4
    v_mfma_f32_32x32x16_bf16 v[112:127], v[56:59], v[164:167], v[112:127]
    ds_read_b64_tr_b16 v[48:49], v19 offset:8192
    ds_read_b64_tr_b16 v[50:51], v19 offset:8704
    s_add_u32 m0, s80, 139264
    s_add_u32 s12, s18, 16384
    buffer_load_dwordx4 v11, s[64:67], s12 offen lds
    v_mul_f32 v13, v13, v5
    v_mul_f32 v14, v14, v6
    v_mul_f32 v15, v15, v7
    v_cvt_pk_bf16_f32 v132, v12, v13
    v_cvt_pk_bf16_f32 v133, v14, v15
    v_smfmac_f32_16x16x64_bf16 v[28:31], v[24:27], v[52:59], v32
    s_waitcnt vmcnt(17) lgkmcnt(0)
    s_barrier
    v_mfma_f32_32x32x16_bf16 v[96:111], v[36:39], v[168:171], v[96:111]
    ds_read_b64_tr_b16 v[52:53], v16 offset:16384
    ds_read_b64_tr_b16 v[54:55], v16 offset:16896
    v_mul_f32 v4, v76, v76
    v_mul_f32 v5, v77, v77
    v_mul_f32 v6, v78, v78
    v_mul_f32 v7, v79, v79
    v_fma_f32 v4, v4, v22, v21
    v_fma_f32 v5, v5, v22, v21
    v_mfma_f32_32x32x16_bf16 v[112:127], v[40:43], v[168:171], v[112:127]
    ds_read_b64_tr_b16 v[56:57], v16 offset:24576
    ds_read_b64_tr_b16 v[58:59], v16 offset:25088
    s_add_u32 m0, s80, 147456
    s_add_u32 s12, s19, 0
    buffer_load_dwordx4 v11, s[64:67], s12 offen lds
    v_fma_f32 v6, v6, v22, v21
    v_fma_f32 v7, v7, v22, v21
    v_mul_f32 v4, v4, v76
    v_mul_f32 v5, v5, v77
    v_mul_f32 v6, v6, v78
    v_mul_f32 v7, v7, v79
    s_waitcnt lgkmcnt(4)
    v_mfma_f32_32x32x16_bf16 v[96:111], v[44:47], v[172:175], v[96:111]
    ds_read_b64_tr_b16 v[36:37], v17 offset:16384
    ds_read_b64_tr_b16 v[38:39], v17 offset:16896
    v_exp_f32 v4, v4
    v_mul_f32 v12, v76, v92
    v_exp_f32 v5, v5
    v_mul_f32 v13, v77, v93
    v_exp_f32 v6, v6
    v_mul_f32 v14, v78, v94
    v_mfma_f32_32x32x16_bf16 v[112:127], v[48:51], v[172:175], v[112:127]
    ds_read_b64_tr_b16 v[40:41], v17 offset:24576
    ds_read_b64_tr_b16 v[42:43], v17 offset:25088
    s_add_u32 m0, s80, 155648
    s_add_u32 s12, s19, 16384
    buffer_load_dwordx4 v11, s[64:67], s12 offen lds
    v_exp_f32 v7, v7
    v_mul_f32 v15, v79, v95
    v_fma_f32 v4, v4, v23, v23
    v_fma_f32 v5, v5, v23, v23
    v_fma_f32 v6, v6, v23, v23
    s_waitcnt lgkmcnt(4)
    v_mfma_f32_32x32x16_bf16 v[96:111], v[52:55], v[176:179], v[96:111]
    ds_read_b64_tr_b16 v[44:45], v18 offset:16384
    ds_read_b64_tr_b16 v[46:47], v18 offset:16896
    v_fma_f32 v7, v7, v23, v23
    v_rcp_f32 v4, v4
    v_rcp_f32 v5, v5
    v_rcp_f32 v6, v6
    v_rcp_f32 v7, v7
    v_mul_f32 v12, v12, v4
    v_mfma_f32_32x32x16_bf16 v[112:127], v[56:59], v[176:179], v[112:127]
    ds_read_b64_tr_b16 v[48:49], v18 offset:24576
    ds_read_b64_tr_b16 v[50:51], v18 offset:25088
    s_add_u32 m0, s80, 0
    s_add_u32 s12, s20, 0
    buffer_load_dwordx4 v11, s[64:67], s12 offen lds
    v_mul_f32 v13, v13, v5
    v_mul_f32 v14, v14, v6
    v_mul_f32 v15, v15, v7
    v_cvt_pk_bf16_f32 v134, v12, v13
    v_cvt_pk_bf16_f32 v135, v14, v15
    buffer_store_dwordx4 v[132:135], v8, s[52:55], s29 offen offset:1024 sc1
    s_add_u32 s29, s29, 4096
    s_waitcnt lgkmcnt(4)
    v_mfma_f32_32x32x16_bf16 v[96:111], v[36:39], v[180:183], v[96:111]
    ds_read_b64_tr_b16 v[52:53], v19 offset:16384
    ds_read_b64_tr_b16 v[54:55], v19 offset:16896
    v_mfma_f32_32x32x16_bf16 v[112:127], v[40:43], v[180:183], v[112:127]
    ds_read_b64_tr_b16 v[56:57], v19 offset:24576
    ds_read_b64_tr_b16 v[58:59], v19 offset:25088
    s_add_u32 m0, s80, 8192
    s_add_u32 s12, s20, 16384
    buffer_load_dwordx4 v11, s[64:67], s12 offen lds
    v_smfmac_f32_16x16x64_bf16 v[28:31], v[24:27], v[36:43], v32
    s_waitcnt vmcnt(7) lgkmcnt(0)
    s_barrier
    v_mfma_f32_32x32x16_bf16 v[96:111], v[44:47], v[184:187], v[96:111]
    ds_read_b64_tr_b16 v[36:37], v16 offset:32768
    ds_read_b64_tr_b16 v[38:39], v16 offset:33280
    ds_read_b64_tr_b16 v[40:41], v16 offset:40960
    v_mov_b32 v136, 0
    v_mov_b32 v137, 0
    v_mov_b32 v138, 0
    v_mov_b32 v139, 0
    v_mov_b32 v140, 0
    v_mov_b32 v141, 0
    v_mfma_f32_32x32x16_bf16 v[112:127], v[48:51], v[184:187], v[112:127]
    ds_read_b64_tr_b16 v[42:43], v16 offset:41472
    v_xor_b32 v16, 65536, v16
    s_add_u32 m0, s80, 16384
    s_add_u32 s12, s16, 65536
    buffer_load_dwordx4 v11, s[64:67], s12 offen lds
    ds_read_b64_tr_b16 v[160:161], v148 offset:49152
    ds_read_b64_tr_b16 v[162:163], v148 offset:50176
    ds_read_b64_tr_b16 v[164:165], v149 offset:49152
    ds_read_b64_tr_b16 v[166:167], v149 offset:50176
    v_mov_b32 v142, 0
    v_mov_b32 v143, 0
    v_mov_b32 v144, 0
    v_mov_b32 v145, 0
    v_mov_b32 v146, 0
    v_mov_b32 v147, 0
    s_waitcnt lgkmcnt(8)
    v_mfma_f32_32x32x16_bf16 v[96:111], v[52:55], v[188:191], v[96:111]
    ds_read_b64_tr_b16 v[44:45], v17 offset:32768
    ds_read_b64_tr_b16 v[46:47], v17 offset:33280
    ds_read_b64_tr_b16 v[48:49], v17 offset:40960
    v_mov_b32 v136, v20
    v_mfma_f32_32x32x16_bf16 v[112:127], v[56:59], v[188:191], v[112:127]
    ds_read_b64_tr_b16 v[50:51], v17 offset:41472
    v_xor_b32 v17, 65536, v17
    ds_read_b64_tr_b16 v[168:169], v148 offset:57344
    ds_read_b64_tr_b16 v[170:171], v148 offset:58368
    ds_read_b64_tr_b16 v[172:173], v149 offset:57344
    ds_read_b64_tr_b16 v[174:175], v149 offset:58368
    s_waitcnt lgkmcnt(12)
    v_mfma_f32_32x32x16_bf16 v[96:111], v[36:39], v[192:195], v[96:111]
    ds_read_b64_tr_b16 v[52:53], v18 offset:32768
    ds_read_b64_tr_b16 v[54:55], v18 offset:33280
    ds_read_b64_tr_b16 v[56:57], v18 offset:40960
    s_lshr_b32 s15, s23, 2
    s_lshl_b32 s15, s15, 4
    v_and_b32 v2, 15, v1
    v_lshlrev_b32 v3, 2, v2
    v_add_u32 v2, s15, v2
    v_lshlrev_b32 v2, 7, v2
    v_bfe_u32 v154, v1, 4, 1
    v_mfma_f32_32x32x16_bf16 v[112:127], v[40:43], v[192:195], v[112:127]
    ds_read_b64_tr_b16 v[58:59], v18 offset:41472
    v_xor_b32 v18, 65536, v18
    s_add_u32 m0, s80, 24576
    s_add_u32 s12, s16, 81920
    buffer_load_dwordx4 v11, s[64:67], s12 offen lds
    buffer_load_dword v60, off, s[72:75], 0 sc1
    ds_read_b64_tr_b16 v[176:177], v150 offset:49152
    ds_read_b64_tr_b16 v[178:179], v150 offset:50176
    ds_read_b64_tr_b16 v[180:181], v151 offset:49152
    ds_read_b64_tr_b16 v[182:183], v151 offset:50176
    v_lshl_add_u32 v3, v154, 7, v3
    v_add_u32 v3, 1792, v3
    v_cmp_gt_u32 vcc, 32, v1
    s_mov_b32 s15, 12582912
    s_nop 0
    v_cndmask_b32 v2, v3, v2, vcc
    v_add_u32 v154, s15, v2
    s_waitcnt lgkmcnt(12)
    v_mfma_f32_32x32x16_bf16 v[96:111], v[44:47], v[196:199], v[96:111]
    ds_read_b64_tr_b16 v[36:37], v19 offset:32768
    ds_read_b64_tr_b16 v[38:39], v19 offset:33280
    ds_read_b64_tr_b16 v[40:41], v19 offset:40960
    v_mfma_f32_32x32x16_bf16 v[112:127], v[48:51], v[196:199], v[112:127]
    ds_read_b64_tr_b16 v[42:43], v19 offset:41472
    v_xor_b32 v19, 65536, v19
    ds_read_b64_tr_b16 v[184:185], v150 offset:57344
    ds_read_b64_tr_b16 v[186:187], v150 offset:58368
    ds_read_b64_tr_b16 v[188:189], v151 offset:57344
    ds_read_b64_tr_b16 v[190:191], v151 offset:58368
    v_smfmac_f32_16x16x64_bf16 v[28:31], v[24:27], v[44:51], v32
    s_waitcnt vmcnt(3) lgkmcnt(0)
    s_barrier
    v_mfma_f32_32x32x16_bf16 v[96:111], v[52:55], v[200:203], v[96:111]
    ds_read_b64_tr_b16 v[44:45], v16 offset:0
    ds_read_b64_tr_b16 v[46:47], v16 offset:512
    v_mfma_f32_32x32x16_bf16 v[112:127], v[56:59], v[200:203], v[112:127]
    ds_read_b64_tr_b16 v[48:49], v16 offset:8192
    ds_read_b64_tr_b16 v[50:51], v16 offset:8704
    s_add_u32 m0, s80, 32768
    s_add_u32 s12, s17, 65536
    buffer_load_dwordx4 v11, s[64:67], s12 offen lds
    ds_read_b64_tr_b16 v[64:65], v152 offset:0
    ds_read_b64_tr_b16 v[66:67], v152 offset:1024
    ds_read_b64_tr_b16 v[68:69], v153 offset:0
    ds_read_b64_tr_b16 v[70:71], v153 offset:1024
    s_waitcnt lgkmcnt(12)
    v_mfma_f32_32x32x16_bf16 v[96:111], v[36:39], v[204:207], v[96:111]
    ds_read_b64_tr_b16 v[52:53], v17 offset:0
    ds_read_b64_tr_b16 v[54:55], v17 offset:512
    v_and_b32 v2, 31, v1
    v_lshl_add_u32 v2, v2, 6, s23
    v_lshlrev_b32 v2, 10, v2
    v_lshrrev_b32 v3, 5, v1
    v_mfma_f32_32x32x16_bf16 v[112:127], v[40:43], v[204:207], v[112:127]
    ds_read_b64_tr_b16 v[56:57], v17 offset:8192
    ds_read_b64_tr_b16 v[58:59], v17 offset:8704
    s_add_u32 m0, s80, 49152
    s_add_u32 s12, s21, 0
    buffer_load_dwordx4 v11, s[64:67], s12 offen lds
    ds_read_b64_tr_b16 v[72:73], v152 offset:8192
    ds_read_b64_tr_b16 v[74:75], v152 offset:9216
    ds_read_b64_tr_b16 v[76:77], v153 offset:8192
    ds_read_b64_tr_b16 v[78:79], v153 offset:9216
    v_lshl_add_u32 v2, v3, 4, v2
    s_lshl_b32 s15, s26, 1
    v_add_u32 v155, s15, v2
    s_waitcnt lgkmcnt(12)
    v_mfma_f32_32x32x16_bf16 v[96:111], v[44:47], v[208:211], v[96:111]
    ds_read_b64_tr_b16 v[36:37], v18 offset:0
    ds_read_b64_tr_b16 v[38:39], v18 offset:512
    v_lshrrev_b32 v2, 3, v1
    s_lshl_b32 s15, s5, 3
    v_add_u32 v2, s15, v2
    v_lshl_add_u32 v3, v2, 6, s23
    v_xor_b32 v3, s25, v3
    v_add_u32 v3, s24, v3
    v_mfma_f32_32x32x16_bf16 v[112:127], v[48:51], v[208:211], v[112:127]
    ds_read_b64_tr_b16 v[40:41], v18 offset:8192
    ds_read_b64_tr_b16 v[42:43], v18 offset:8704
    s_add_u32 m0, s80, 40960
    s_add_u32 s12, s17, 81920
    buffer_load_dwordx4 v11, s[64:67], s12 offen lds
    ds_read_b64_tr_b16 v[80:81], v152 offset:16384
    ds_read_b64_tr_b16 v[82:83], v152 offset:17408
    ds_read_b64_tr_b16 v[84:85], v153 offset:16384
    ds_read_b64_tr_b16 v[86:87], v153 offset:17408
    v_and_b32 v3, 0x7ff, v3
    v_lshrrev_b32 v2, 1, v2
    v_xor_b32 v2, v2, v1
    v_and_b32 v2, 7, v2
    v_lshlrev_b32 v2, 4, v2
    v_lshl_add_u32 v9, v3, 12, v2
    s_waitcnt lgkmcnt(12)
    v_mfma_f32_32x32x16_bf16 v[96:111], v[52:55], v[212:215], v[96:111]
    ds_read_b64_tr_b16 v[44:45], v19 offset:0
    ds_read_b64_tr_b16 v[46:47], v19 offset:512
    v_and_b32 v2, 15, v1
    v_add_u32 v2, s26, v2
    v_xor_b32 v2, s25, v2
    v_add_u32 v2, s24, v2
    v_and_b32 v2, 0x1ff, v2
    v_mfma_f32_32x32x16_bf16 v[112:127], v[56:59], v[212:215], v[112:127]
    ds_read_b64_tr_b16 v[48:49], v19 offset:8192
    ds_read_b64_tr_b16 v[50:51], v19 offset:8704
    s_add_u32 m0, s80, 57344
    s_add_u32 s12, s21, 16384
    buffer_load_dwordx4 v11, s[64:67], s12 offen lds
    ds_read_b64_tr_b16 v[88:89], v152 offset:24576
    ds_read_b64_tr_b16 v[90:91], v152 offset:25600
    ds_read_b64_tr_b16 v[92:93], v153 offset:24576
    ds_read_b64_tr_b16 v[94:95], v153 offset:25600
    v_lshrrev_b32 v3, 4, v1
    v_mul_u32_u24 v3, 288, v3
    v_add_u32 v2, v2, v3
    v_lshl_add_u32 v156, v2, 4, s27
    v_smfmac_f32_16x16x64_bf16 v[28:31], v[24:27], v[52:59], v32
    s_waitcnt vmcnt(4) lgkmcnt(0)
L_armF:
    v_readfirstlane_b32 s12, v60
    s_add_u32 s84, s84, 1
    s_cmp_lg_u32 s12, 0
    s_cbranch_scc1 L_armdF
    buffer_load_dword v60, off, s[72:75], 0 sc1
    s_waitcnt vmcnt(0)
    s_cmp_lt_u32 s84, 200000
    s_cbranch_scc1 L_armF
L_armdF:
    s_barrier
    v_mov_b32 v2, s30
    v_mov_b32 v3, 1
    s_mov_b64 exec, 1
    buffer_store_dword v3, v2, s[52:55], 0 offen sc1
    s_mov_b64 exec, -1
    v_mfma_f32_32x32x16_bf16 v[96:111], v[36:39], v[216:219], v[96:111]
    ds_read_b64_tr_b16 v[52:53], v16 offset:16384
    ds_read_b64_tr_b16 v[54:55], v16 offset:16896
    v_mfma_f32_32x32x16_bf16 v[112:127], v[40:43], v[216:219], v[112:127]
    ds_read_b64_tr_b16 v[56:57], v16 offset:24576
    ds_read_b64_tr_b16 v[58:59], v16 offset:25088
    s_add_u32 m0, s80, 114688
    s_add_u32 s12, s22, 0
    buffer_load_dwordx4 v11, s[64:67], s12 offen lds
    ds_read_b64_tr_b16 v[192:193], v148 offset:0
    ds_read_b64_tr_b16 v[194:195], v148 offset:1024
    ds_read_b64_tr_b16 v[196:197], v149 offset:0
    ds_read_b64_tr_b16 v[198:199], v149 offset:1024
    s_waitcnt lgkmcnt(12)
    v_mfma_f32_32x32x16_bf16 v[96:111], v[44:47], v[220:223], v[96:111]
    ds_read_b64_tr_b16 v[36:37], v17 offset:16384
    ds_read_b64_tr_b16 v[38:39], v17 offset:16896
    v_mfma_f32_32x32x16_bf16 v[112:127], v[48:51], v[220:223], v[112:127]
    ds_read_b64_tr_b16 v[40:41], v17 offset:24576
    ds_read_b64_tr_b16 v[42:43], v17 offset:25088
    s_add_u32 m0, s80, 122880
    s_add_u32 s12, s22, 16384
    buffer_load_dwordx4 v11, s[64:67], s12 offen lds
    ds_read_b64_tr_b16 v[200:201], v148 offset:8192
    ds_read_b64_tr_b16 v[202:203], v148 offset:9216
    ds_read_b64_tr_b16 v[204:205], v149 offset:8192
    ds_read_b64_tr_b16 v[206:207], v149 offset:9216
    s_waitcnt lgkmcnt(12)
    v_mfma_f32_32x32x16_bf16 v[96:111], v[52:55], v[224:227], v[96:111]
    ds_read_b64_tr_b16 v[44:45], v18 offset:16384
    ds_read_b64_tr_b16 v[46:47], v18 offset:16896
    v_bfe_u32 v2, v1, 1, 3
    v_lshlrev_b32 v2, 4, v2
    v_and_b32 v3, 31, v1
    v_lshl_add_u32 v2, v3, 7, v2
    v_lshrrev_b32 v3, 5, v1
    v_mfma_f32_32x32x16_bf16 v[112:127], v[56:59], v[224:227], v[112:127]
    ds_read_b64_tr_b16 v[48:49], v18 offset:24576
    ds_read_b64_tr_b16 v[50:51], v18 offset:25088
    s_add_u32 m0, s80, 65536
    s_add_u32 s12, s18, 65536
    buffer_load_dwordx4 v11, s[64:67], s12 offen lds
    v_lshl_add_u32 v2, v3, 3, v2
    s_lshl_b32 s15, s4, 12
    s_add_u32 s15, s15, 0
    v_add_u32 v157, s15, v2
    s_waitcnt lgkmcnt(8)
    v_mfma_f32_32x32x16_bf16 v[96:111], v[36:39], v[228:231], v[96:111]
    ds_read_b64_tr_b16 v[52:53], v19 offset:16384
    ds_read_b64_tr_b16 v[54:55], v19 offset:16896
    v_mfma_f32_32x32x16_bf16 v[112:127], v[40:43], v[228:231], v[112:127]
    ds_read_b64_tr_b16 v[56:57], v19 offset:24576
    ds_read_b64_tr_b16 v[58:59], v19 offset:25088
    s_add_u32 m0, s80, 73728
    s_add_u32 s12, s18, 81920
    buffer_load_dwordx4 v11, s[64:67], s12 offen lds
    v_smfmac_f32_16x16x64_bf16 v[28:31], v[24:27], v[36:43], v32
    s_waitcnt vmcnt(24) lgkmcnt(0)
    s_barrier
    v_mfma_f32_32x32x16_bf16 v[96:111], v[44:47], v[232:235], v[96:111]
    ds_read_b64_tr_b16 v[36:37], v16 offset:32768
    ds_read_b64_tr_b16 v[38:39], v16 offset:33280
    v_mfma_f32_32x32x16_bf16 v[112:127], v[48:51], v[232:235], v[112:127]
    ds_read_b64_tr_b16 v[40:41], v16 offset:40960
    ds_read_b64_tr_b16 v[42:43], v16 offset:41472
    s_add_u32 m0, s80, 131072
    s_add_u32 s12, s19, 65536
    buffer_load_dwordx4 v11, s[64:67], s12 offen lds
    s_waitcnt lgkmcnt(4)
    v_mfma_f32_32x32x16_bf16 v[96:111], v[52:55], v[236:239], v[96:111]
    ds_read_b64_tr_b16 v[44:45], v17 offset:32768
    ds_read_b64_tr_b16 v[46:47], v17 offset:33280
    v_mfma_f32_32x32x16_bf16 v[112:127], v[56:59], v[236:239], v[112:127]
    ds_read_b64_tr_b16 v[48:49], v17 offset:40960
    ds_read_b64_tr_b16 v[50:51], v17 offset:41472
    s_add_u32 m0, s80, 139264
    s_add_u32 s12, s19, 81920
    buffer_load_dwordx4 v11, s[64:67], s12 offen lds
    s_waitcnt lgkmcnt(4)
    v_mfma_f32_32x32x16_bf16 v[96:111], v[36:39], v[240:243], v[96:111]
    ds_read_b64_tr_b16 v[52:53], v18 offset:32768
    ds_read_b64_tr_b16 v[54:55], v18 offset:33280
    v_mfma_f32_32x32x16_bf16 v[112:127], v[40:43], v[240:243], v[112:127]
    ds_read_b64_tr_b16 v[56:57], v18 offset:40960
    ds_read_b64_tr_b16 v[58:59], v18 offset:41472
    s_add_u32 m0, s80, 147456
    s_add_u32 s12, s20, 65536
    buffer_load_dwordx4 v11, s[64:67], s12 offen lds
    s_waitcnt lgkmcnt(4)
    v_mfma_f32_32x32x16_bf16 v[96:111], v[44:47], v[244:247], v[96:111]
    ds_read_b64_tr_b16 v[36:37], v19 offset:32768
    ds_read_b64_tr_b16 v[38:39], v19 offset:33280
    v_mfma_f32_32x32x16_bf16 v[112:127], v[48:51], v[244:247], v[112:127]
    ds_read_b64_tr_b16 v[40:41], v19 offset:40960
    ds_read_b64_tr_b16 v[42:43], v19 offset:41472
    s_add_u32 m0, s80, 155648
    s_add_u32 s12, s20, 81920
    buffer_load_dwordx4 v11, s[64:67], s12 offen lds
    s_mov_b32 exec_lo, s82
    s_mov_b32 exec_hi, 0
    buffer_load_dword v60, v154, s[52:55], 0 offen sc1
    s_mov_b64 exec, -1
    v_smfmac_f32_16x16x64_bf16 v[28:31], v[24:27], v[44:51], v32
    s_nop 11
    v_add_f32 v34, v28, v29
    v_add_f32 v35, v30, v31
    v_add_u32 v3, 94208, v62
    ds_write_b64 v3, v[34:35]
    v_mov_b32 v28, 0
    v_mov_b32 v29, 0
    v_mov_b32 v30, 0
    v_mov_b32 v31, 0
    s_waitcnt lgkmcnt(0)
    s_barrier
    v_add_u32 v3, 94208, v63
    ds_read2_b64 v[4:7], v3 offset0:0 offset1:128
    v_mfma_f32_32x32x16_bf16 v[96:111], v[52:55], v[248:251], v[96:111]
    v_mfma_f32_32x32x16_bf16 v[112:127], v[56:59], v[248:251], v[112:127]
    s_add_u32 m0, s85, 0
    s_nop 0
    buffer_load_dwordx4 v9, s[56:59], 0 offen lds
    v_mfma_f32_32x32x16_bf16 v[96:111], v[36:39], v[252:255], v[96:111]
    s_waitcnt lgkmcnt(0)
    v_add_f32 v4, v4, v6
    v_add_f32 v5, v5, v7
    v_cvt_pk_bf16_f32 v6, v4, v4
    v_cvt_pk_bf16_f32 v7, v5, v5
    v_lshlrev_b32 v6, 16, v6
    v_mfma_f32_32x32x16_bf16 v[112:127], v[40:43], v[252:255], v[112:127]
    s_add_u32 m0, s85, 8192
    s_nop 0
    buffer_load_dwordx4 v9, s[60:63], 0 offen lds
    v_lshlrev_b32 v7, 16, v7
    v_sub_f32 v4, v4, v6
    v_sub_f32 v5, v5, v7
    v_cvt_pk_bf16_f32 v140, v6, v4
    v_cvt_pk_bf16_f32 v144, v7, v5
    s_nop 0
    v_mfma_f32_32x32x16_bf16 v[96:111], v[140:143], v[136:139], v[96:111]
    v_mfma_f32_32x32x16_bf16 v[112:127], v[144:147], v[136:139], v[112:127]
    s_waitcnt vmcnt(2)
    s_mov_b32 s31, 1
    v_cmp_le_u32 vcc, 1, v60
    s_nop 0
    s_and_b32 s10, vcc_lo, s82
    s_cmp_eq_u32 s10, s82
    s_cbranch_scc1 L_fastA
    s_mov_b32 s31, 0
    s_branch L_epiB
L_fastA:
    s_lshr_b32 s83, s16, 4
    s_add_u32 s83, s83, s81
    buffer_load_dwordx4 v[208:211], v8, s[52:55], s83 offen offset:0 sc1
    buffer_load_dwordx4 v[212:215], v8, s[52:55], s83 offen offset:1024 sc1
    s_lshr_b32 s83, s17, 4
    s_add_u32 s83, s83, s81
    buffer_load_dwordx4 v[216:219], v8, s[52:55], s83 offen offset:0 sc1
    buffer_load_dwordx4 v[220:223], v8, s[52:55], s83 offen offset:1024 sc1
    s_lshr_b32 s83, s18, 4
    s_add_u32 s83, s83, s81
    buffer_load_dwordx4 v[224:227], v8, s[52:55], s83 offen offset:0 sc1
    buffer_load_dwordx4 v[228:231], v8, s[52:55], s83 offen offset:1024 sc1
    s_lshr_b32 s83, s19, 4
    s_add_u32 s83, s83, s81
    buffer_load_dwordx4 v[232:235], v8, s[52:55], s83 offen offset:0 sc1
L_epiB:
    s_lshl_b32 s15, s3, 10
    v_add_u32 v16, s15, v8
    v_add_u32 v18, 0, v16
    v_xor_b32 v25, 3072, v18
    v_add_u32 v17, 65536, v16
    v_xor_b32 v24, 2048, v17
    v_add_u32 v16, 0, v16
    v_xor_b32 v19, 1024, v16
    s_nop 7
    v_mul_f32 v36, v96, v96
    v_mul_f32 v37, v97, v97
    v_mul_f32 v38, v98, v98
    v_mul_f32 v39, v99, v99
    v_mul_f32 v40, v100, v100
    v_mul_f32 v41, v101, v101
    v_mul_f32 v42, v102, v102
    v_mul_f32 v43, v103, v103
    v_fma_f32 v36, v36, v22, v21
    v_fma_f32 v37, v37, v22, v21
    v_fma_f32 v38, v38, v22, v21
    v_fma_f32 v39, v39, v22, v21
    v_fma_f32 v40, v40, v22, v21
    v_fma_f32 v41, v41, v22, v21
    v_fma_f32 v42, v42, v22, v21
    v_fma_f32 v43, v43, v22, v21
    v_mul_f32 v36, v36, v96
    v_mul_f32 v37, v37, v97
    v_mul_f32 v38, v38, v98
    v_mul_f32 v39, v39, v99
    v_mul_f32 v40, v40, v100
    v_mul_f32 v41, v41, v101
    v_mul_f32 v42, v42, v102
    v_mul_f32 v43, v43, v103
    v_exp_f32 v36, v36
    v_mul_f32 v44, v96, v112
    v_exp_f32 v37, v37
    v_mul_f32 v45, v97, v113
    v_exp_f32 v38, v38
    v_mul_f32 v46, v98, v114
    v_exp_f32 v39, v39
    v_mul_f32 v47, v99, v115
    v_exp_f32 v40, v40
    v_mul_f32 v48, v100, v116
    v_exp_f32 v41, v41
    v_mul_f32 v49, v101, v117
    v_exp_f32 v42, v42
    v_mul_f32 v50, v102, v118
    v_exp_f32 v43, v43
    v_mul_f32 v51, v103, v119
    v_fma_f32 v36, v36, v23, v23
    v_fma_f32 v37, v37, v23, v23
    v_fma_f32 v38, v38, v23, v23
    v_fma_f32 v39, v39, v23, v23
    v_fma_f32 v40, v40, v23, v23
    v_fma_f32 v41, v41, v23, v23
    v_fma_f32 v42, v42, v23, v23
    v_fma_f32 v43, v43, v23, v23
    v_rcp_f32 v36, v36
    v_rcp_f32 v37, v37
    v_rcp_f32 v38, v38
    v_rcp_f32 v39, v39
    v_rcp_f32 v40, v40
    v_rcp_f32 v41, v41
    v_rcp_f32 v42, v42
    v_rcp_f32 v43, v43
    v_mul_f32 v44, v44, v36
    v_mul_f32 v45, v45, v37
    v_mul_f32 v46, v46, v38
    v_mul_f32 v47, v47, v39
    v_mul_f32 v48, v48, v40
    v_mul_f32 v49, v49, v41
    v_mul_f32 v50, v50, v42
    v_mul_f32 v51, v51, v43
    v_cvt_pk_bf16_f32 v128, v44, v45
    v_cvt_pk_bf16_f32 v129, v46, v47
    v_cvt_pk_bf16_f32 v130, v48, v49
    v_cvt_pk_bf16_f32 v131, v50, v51
    buffer_store_dwordx4 v[128:131], v8, s[52:55], s29 offen offset:0 sc1
    v_mul_f32 v36, v104, v104
    v_mul_f32 v37, v105, v105
    v_mul_f32 v38, v106, v106
    v_mul_f32 v39, v107, v107
    v_mul_f32 v40, v108, v108
    v_mul_f32 v41, v109, v109
    v_mul_f32 v42, v110, v110
    v_mul_f32 v43, v111, v111
    v_fma_f32 v36, v36, v22, v21
    v_fma_f32 v37, v37, v22, v21
    v_fma_f32 v38, v38, v22, v21
    v_fma_f32 v39, v39, v22, v21
    v_fma_f32 v40, v40, v22, v21
    v_fma_f32 v41, v41, v22, v21
    v_fma_f32 v42, v42, v22, v21
    v_fma_f32 v43, v43, v22, v21
    v_mul_f32 v36, v36, v104
    v_mul_f32 v37, v37, v105
    v_mul_f32 v38, v38, v106
    v_mul_f32 v39, v39, v107
    v_mul_f32 v40, v40, v108
    v_mul_f32 v41, v41, v109
    v_mul_f32 v42, v42, v110
    v_mul_f32 v43, v43, v111
    v_exp_f32 v36, v36
    v_mul_f32 v44, v104, v120
    v_exp_f32 v37, v37
    v_mul_f32 v45, v105, v121
    v_exp_f32 v38, v38
    v_mul_f32 v46, v106, v122
    v_exp_f32 v39, v39
    v_mul_f32 v47, v107, v123
    v_exp_f32 v40, v40
    v_mul_f32 v48, v108, v124
    v_exp_f32 v41, v41
    v_mul_f32 v49, v109, v125
    v_exp_f32 v42, v42
    v_mul_f32 v50, v110, v126
    v_exp_f32 v43, v43
    v_mul_f32 v51, v111, v127
    v_fma_f32 v36, v36, v23, v23
    v_fma_f32 v37, v37, v23, v23
    v_fma_f32 v38, v38, v23, v23
    v_fma_f32 v39, v39, v23, v23
    v_fma_f32 v40, v40, v23, v23
    v_fma_f32 v41, v41, v23, v23
    v_fma_f32 v42, v42, v23, v23
    v_fma_f32 v43, v43, v23, v23
    v_rcp_f32 v36, v36
    v_rcp_f32 v37, v37
    v_rcp_f32 v38, v38
    v_rcp_f32 v39, v39
    v_rcp_f32 v40, v40
    v_rcp_f32 v41, v41
    v_rcp_f32 v42, v42
    v_rcp_f32 v43, v43
    v_mul_f32 v44, v44, v36
    v_mul_f32 v45, v45, v37
    v_mul_f32 v46, v46, v38
    v_mul_f32 v47, v47, v39
    v_mul_f32 v48, v48, v40
    v_mul_f32 v49, v49, v41
    v_mul_f32 v50, v50, v42
    v_mul_f32 v51, v51, v43
    v_cvt_pk_bf16_f32 v132, v44, v45
    v_cvt_pk_bf16_f32 v133, v46, v47
    v_cvt_pk_bf16_f32 v134, v48, v49
    v_cvt_pk_bf16_f32 v135, v50, v51
    buffer_store_dwordx4 v[132:135], v8, s[52:55], s29 offen offset:1024 sc1
    s_cmp_eq_u32 s31, 1
    s_cbranch_scc1 L_goA
    s_waitcnt vmcnt(0)
    s_barrier
    v_mov_b32 v2, s30
    v_mov_b32 v3, 2
    s_mov_b64 exec, 1
    buffer_store_dword v3, v2, s[52:55], 0 offen sc1
    s_mov_b64 exec, -1
L_apF:
    s_mov_b32 exec_lo, s82
    s_mov_b32 exec_hi, 0
    buffer_load_dword v60, v154, s[52:55], 0 offen sc1
    s_mov_b64 exec, -1
    s_waitcnt vmcnt(0)
    v_cmp_le_u32 vcc, 1, v60
    s_nop 0
    s_and_b32 s10, vcc_lo, s82
    s_cmp_eq_u32 s10, s82
    s_cbranch_scc1 L_apdF
    s_add_u32 s84, s84, 1
    s_cmp_lt_u32 s84, 200000
    s_cbranch_scc1 L_apF
L_apdF:
    s_lshr_b32 s83, s16, 4
    s_add_u32 s83, s83, s81
    buffer_load_dwordx4 v[208:211], v8, s[52:55], s83 offen offset:0 sc1
    buffer_load_dwordx4 v[212:215], v8, s[52:55], s83 offen offset:1024 sc1
    s_lshr_b32 s83, s17, 4
    s_add_u32 s83, s83, s81
    buffer_load_dwordx4 v[216:219], v8, s[52:55], s83 offen offset:0 sc1
    buffer_load_dwordx4 v[220:223], v8, s[52:55], s83 offen offset:1024 sc1
    s_lshr_b32 s83, s18, 4
    s_add_u32 s83, s83, s81
    buffer_load_dwordx4 v[224:227], v8, s[52:55], s83 offen offset:0 sc1
    buffer_load_dwordx4 v[228:231], v8, s[52:55], s83 offen offset:1024 sc1
    s_lshr_b32 s83, s19, 4
    s_add_u32 s83, s83, s81
    buffer_load_dwordx4 v[232:235], v8, s[52:55], s83 offen offset:0 sc1
L_goA:
    s_waitcnt vmcnt(6)
    v_mfma_f32_32x32x16_bf16 v[96:111], v[160:163], v[208:211], 0
    v_mfma_f32_32x32x16_bf16 v[112:127], v[164:167], v[208:211], 0
    buffer_load_dwordx4 v[236:239], v8, s[52:55], s83 offen offset:1024 sc1
    s_add_u32 m0, s80, 81920
    s_add_u32 s12, s21, 65536
    buffer_load_dwordx4 v11, s[64:67], s12 offen lds
    s_waitcnt vmcnt(7)
    s_cmp_eq_u32 s31, 0
    s_cbranch_scc1 L_pubd
    s_waitcnt vmcnt(2)
    s_barrier
    v_mov_b32 v2, s30
    v_mov_b32 v3, 2
    s_mov_b64 exec, 1
    buffer_store_dword v3, v2, s[52:55], 0 offen sc1
    s_mov_b64 exec, -1
L_pubd:
    v_mfma_f32_32x32x16_bf16 v[96:111], v[168:171], v[212:215], v[96:111]
    v_mfma_f32_32x32x16_bf16 v[112:127], v[172:175], v[212:215], v[112:127]
    s_lshr_b32 s83, s20, 4
    s_add_u32 s83, s83, s81
    buffer_load_dwordx4 v[240:243], v8, s[52:55], s83 offen offset:0 sc1
    s_add_u32 m0, s80, 90112
    s_add_u32 s12, s21, 81920
    buffer_load_dwordx4 v11, s[64:67], s12 offen lds
    s_add_u32 m0, s80, 98304
    s_add_u32 s12, s22, 65536
    buffer_load_dwordx4 v11, s[64:67], s12 offen lds
    s_waitcnt vmcnt(9)
    v_mfma_f32_32x32x16_bf16 v[96:111], v[176:179], v[216:219], v[96:111]
    v_mfma_f32_32x32x16_bf16 v[112:127], v[180:183], v[216:219], v[112:127]
    buffer_load_dwordx4 v[244:247], v8, s[52:55], s83 offen offset:1024 sc1
    s_add_u32 m0, s80, 106496
    s_add_u32 s12, s22, 81920
    buffer_load_dwordx4 v11, s[64:67], s12 offen lds
    s_waitcnt vmcnt(10)
    v_mfma_f32_32x32x16_bf16 v[96:111], v[184:187], v[220:223], v[96:111]
    v_mfma_f32_32x32x16_bf16 v[112:127], v[188:191], v[220:223], v[112:127]
    s_lshr_b32 s83, s21, 4
    s_add_u32 s83, s83, s81
    buffer_load_dwordx4 v[208:211], v8, s[52:55], s83 offen offset:0 sc1
    buffer_load_dwordx4 v[248:251], v155, s[40:43], 0 offen
    s_waitcnt vmcnt(11)
    v_mfma_f32_32x32x16_bf16 v[96:111], v[64:67], v[224:227], v[96:111]
    v_mfma_f32_32x32x16_bf16 v[112:127], v[68:71], v[224:227], v[112:127]
    buffer_load_dwordx4 v[212:215], v8, s[52:55], s83 offen offset:1024 sc1
    s_mov_b32 exec_lo, s82
    s_mov_b32 exec_hi, 0
    buffer_load_dword v5, v154, s[52:55], 0 offen sc1
    s_mov_b64 exec, -1
    s_waitcnt vmcnt(12)
    v_mfma_f32_32x32x16_bf16 v[96:111], v[72:75], v[228:231], v[96:111]
    v_mfma_f32_32x32x16_bf16 v[112:127], v[76:79], v[228:231], v[112:127]
    s_lshr_b32 s83, s22, 4
    s_add_u32 s83, s83, s81
    buffer_load_dwordx4 v[216:219], v8, s[52:55], s83 offen offset:0 sc1
    s_waitcnt vmcnt(12)
    v_mfma_f32_32x32x16_bf16 v[96:111], v[80:83], v[232:235], v[96:111]
    v_mfma_f32_32x32x16_bf16 v[112:127], v[84:87], v[232:235], v[112:127]
    buffer_load_dwordx4 v[220:223], v8, s[52:55], s83 offen offset:1024 sc1
    s_waitcnt vmcnt(2)
    v_cmp_le_u32 vcc, 2, v5
    s_nop 0
    s_and_b32 s10, vcc_lo, s82
    s_cmp_eq_u32 s10, s82
    s_cbranch_scc1 L_fastBF
    s_waitcnt vmcnt(12)
    v_mfma_f32_32x32x16_bf16 v[96:111], v[88:91], v[236:239], v[96:111]
    v_mfma_f32_32x32x16_bf16 v[112:127], v[92:95], v[236:239], v[112:127]
    ds_read_b64_tr_b16 v[44:45], v148 offset:49152
    ds_read_b64_tr_b16 v[46:47], v148 offset:50176
    ds_read_b64_tr_b16 v[48:49], v149 offset:49152
    ds_read_b64_tr_b16 v[50:51], v149 offset:50176
    s_waitcnt vmcnt(10)
    v_mfma_f32_32x32x16_bf16 v[96:111], v[192:195], v[240:243], v[96:111]
    v_mfma_f32_32x32x16_bf16 v[112:127], v[196:199], v[240:243], v[112:127]
    ds_read_b64_tr_b16 v[52:53], v148 offset:57344
    ds_read_b64_tr_b16 v[54:55], v148 offset:58368
    ds_read_b64_tr_b16 v[56:57], v149 offset:57344
    ds_read_b64_tr_b16 v[58:59], v149 offset:58368
    s_waitcnt vmcnt(7)
    v_mfma_f32_32x32x16_bf16 v[96:111], v[200:203], v[244:247], v[96:111]
    v_mfma_f32_32x32x16_bf16 v[112:127], v[204:207], v[244:247], v[112:127]
    ds_read_b64_tr_b16 v[36:37], v150 offset:49152
    ds_read_b64_tr_b16 v[38:39], v150 offset:50176
    ds_read_b64_tr_b16 v[40:41], v151 offset:49152
    ds_read_b64_tr_b16 v[42:43], v151 offset:50176
    s_waitcnt vmcnt(5) lgkmcnt(8)
    v_mfma_f32_32x32x16_bf16 v[96:111], v[44:47], v[208:211], v[96:111]
    v_mfma_f32_32x32x16_bf16 v[112:127], v[48:51], v[208:211], v[112:127]
    ds_read_b64_tr_b16 v[44:45], v150 offset:57344
    ds_read_b64_tr_b16 v[46:47], v150 offset:58368
    ds_read_b64_tr_b16 v[48:49], v151 offset:57344
    ds_read_b64_tr_b16 v[50:51], v151 offset:58368
    s_waitcnt vmcnt(3) lgkmcnt(8)
    v_mfma_f32_32x32x16_bf16 v[96:111], v[52:55], v[212:215], v[96:111]
    v_mfma_f32_32x32x16_bf16 v[112:127], v[56:59], v[212:215], v[112:127]
    ds_read_b64_tr_b16 v[52:53], v148 offset:16384
    ds_read_b64_tr_b16 v[54:55], v148 offset:17408
    ds_read_b64_tr_b16 v[56:57], v149 offset:16384
    ds_read_b64_tr_b16 v[58:59], v149 offset:17408
    s_waitcnt vmcnt(1) lgkmcnt(8)
    v_mfma_f32_32x32x16_bf16 v[96:111], v[36:39], v[216:219], v[96:111]
    v_mfma_f32_32x32x16_bf16 v[112:127], v[40:43], v[216:219], v[112:127]
    ds_read_b64_tr_b16 v[36:37], v148 offset:24576
    ds_read_b64_tr_b16 v[38:39], v148 offset:25600
    ds_read_b64_tr_b16 v[40:41], v149 offset:24576
    ds_read_b64_tr_b16 v[42:43], v149 offset:25600
    s_waitcnt vmcnt(0) lgkmcnt(8)
    v_mfma_f32_32x32x16_bf16 v[96:111], v[44:47], v[220:223], v[96:111]
    v_mfma_f32_32x32x16_bf16 v[112:127], v[48:51], v[220:223], v[112:127]
L_bpF:
    s_mov_b32 exec_lo, s82
    s_mov_b32 exec_hi, 0
    buffer_load_dword v5, v154, s[52:55], 0 offen sc1
    s_mov_b64 exec, -1
    s_waitcnt vmcnt(0)
    v_cmp_le_u32 vcc, 2, v5
    s_nop 0
    s_and_b32 s10, vcc_lo, s82
    s_cmp_eq_u32 s10, s82
    s_cbranch_scc1 L_bpdF
    s_add_u32 s84, s84, 1
    s_cmp_lt_u32 s84, 200000
    s_cbranch_scc1 L_bpF
L_bpdF:
    s_lshr_b32 s83, s16, 4
    s_add_u32 s83, s83, s79
    buffer_load_dwordx4 v[224:227], v8, s[52:55], s83 offen offset:0 sc1
    buffer_load_dwordx4 v[228:231], v8, s[52:55], s83 offen offset:1024 sc1
    s_lshr_b32 s83, s17, 4
    s_add_u32 s83, s83, s79
    buffer_load_dwordx4 v[232:235], v8, s[52:55], s83 offen offset:0 sc1
    buffer_load_dwordx4 v[236:239], v8, s[52:55], s83 offen offset:1024 sc1
    s_lshr_b32 s83, s18, 4
    s_add_u32 s83, s83, s79
    buffer_load_dwordx4 v[240:243], v8, s[52:55], s83 offen offset:0 sc1
    buffer_load_dwordx4 v[244:247], v8, s[52:55], s83 offen offset:1024 sc1
    s_lshr_b32 s83, s19, 4
    s_add_u32 s83, s83, s79
    buffer_load_dwordx4 v[208:211], v8, s[52:55], s83 offen offset:0 sc1
    s_branch L_joinBF
L_fastBF:
    s_waitcnt vmcnt(12)
    v_mfma_f32_32x32x16_bf16 v[96:111], v[88:91], v[236:239], v[96:111]
    v_mfma_f32_32x32x16_bf16 v[112:127], v[92:95], v[236:239], v[112:127]
    s_lshr_b32 s83, s16, 4
    s_add_u32 s83, s83, s79
    buffer_load_dwordx4 v[224:227], v8, s[52:55], s83 offen offset:0 sc1
    ds_read_b64_tr_b16 v[44:45], v148 offset:49152
    ds_read_b64_tr_b16 v[46:47], v148 offset:50176
    ds_read_b64_tr_b16 v[48:49], v149 offset:49152
    ds_read_b64_tr_b16 v[50:51], v149 offset:50176
    s_waitcnt vmcnt(11)
    v_mfma_f32_32x32x16_bf16 v[96:111], v[192:195], v[240:243], v[96:111]
    v_mfma_f32_32x32x16_bf16 v[112:127], v[196:199], v[240:243], v[112:127]
    buffer_load_dwordx4 v[228:231], v8, s[52:55], s83 offen offset:1024 sc1
    ds_read_b64_tr_b16 v[52:53], v148 offset:57344
    ds_read_b64_tr_b16 v[54:55], v148 offset:58368
    ds_read_b64_tr_b16 v[56:57], v149 offset:57344
    ds_read_b64_tr_b16 v[58:59], v149 offset:58368
    s_waitcnt vmcnt(9)
    v_mfma_f32_32x32x16_bf16 v[96:111], v[200:203], v[244:247], v[96:111]
    v_mfma_f32_32x32x16_bf16 v[112:127], v[204:207], v[244:247], v[112:127]
    s_lshr_b32 s83, s17, 4
    s_add_u32 s83, s83, s79
    buffer_load_dwordx4 v[232:235], v8, s[52:55], s83 offen offset:0 sc1
    ds_read_b64_tr_b16 v[36:37], v150 offset:49152
    ds_read_b64_tr_b16 v[38:39], v150 offset:50176
    ds_read_b64_tr_b16 v[40:41], v151 offset:49152
    ds_read_b64_tr_b16 v[42:43], v151 offset:50176
    s_waitcnt vmcnt(8) lgkmcnt(8)
    v_mfma_f32_32x32x16_bf16 v[96:111], v[44:47], v[208:211], v[96:111]
    v_mfma_f32_32x32x16_bf16 v[112:127], v[48:51], v[208:211], v[112:127]
    buffer_load_dwordx4 v[236:239], v8, s[52:55], s83 offen offset:1024 sc1
    ds_read_b64_tr_b16 v[44:45], v150 offset:57344
    ds_read_b64_tr_b16 v[46:47], v150 offset:58368
    ds_read_b64_tr_b16 v[48:49], v151 offset:57344
    ds_read_b64_tr_b16 v[50:51], v151 offset:58368
    s_waitcnt vmcnt(7) lgkmcnt(8)
    v_mfma_f32_32x32x16_bf16 v[96:111], v[52:55], v[212:215], v[96:111]
    v_mfma_f32_32x32x16_bf16 v[112:127], v[56:59], v[212:215], v[112:127]
    s_lshr_b32 s83, s18, 4
    s_add_u32 s83, s83, s79
    buffer_load_dwordx4 v[240:243], v8, s[52:55], s83 offen offset:0 sc1
    ds_read_b64_tr_b16 v[52:53], v148 offset:16384
    ds_read_b64_tr_b16 v[54:55], v148 offset:17408
    ds_read_b64_tr_b16 v[56:57], v149 offset:16384
    ds_read_b64_tr_b16 v[58:59], v149 offset:17408
    s_waitcnt vmcnt(6) lgkmcnt(8)
    v_mfma_f32_32x32x16_bf16 v[96:111], v[36:39], v[216:219], v[96:111]
    v_mfma_f32_32x32x16_bf16 v[112:127], v[40:43], v[216:219], v[112:127]
    buffer_load_dwordx4 v[244:247], v8, s[52:55], s83 offen offset:1024 sc1
    ds_read_b64_tr_b16 v[36:37], v148 offset:24576
    ds_read_b64_tr_b16 v[38:39], v148 offset:25600
    ds_read_b64_tr_b16 v[40:41], v149 offset:24576
    ds_read_b64_tr_b16 v[42:43], v149 offset:25600
    s_waitcnt vmcnt(6) lgkmcnt(8)
    v_mfma_f32_32x32x16_bf16 v[96:111], v[44:47], v[220:223], v[96:111]
    v_mfma_f32_32x32x16_bf16 v[112:127], v[48:51], v[220:223], v[112:127]
    s_lshr_b32 s83, s19, 4
    s_add_u32 s83, s83, s79
    buffer_load_dwordx4 v[208:211], v8, s[52:55], s83 offen offset:0 sc1
L_joinBF:
    s_mov_b32 exec_lo, 0
    buffer_load_dword v3, v154, s[52:55], 0 offen sc1
    s_mov_b64 exec, -1
    ds_read_b64_tr_b16 v[44:45], v148 offset:32768
    ds_read_b64_tr_b16 v[46:47], v148 offset:33792
    ds_read_b64_tr_b16 v[48:49], v149 offset:32768
    ds_read_b64_tr_b16 v[50:51], v149 offset:33792
    s_waitcnt vmcnt(7) lgkmcnt(8)
    v_mfma_f32_32x32x16_bf16 v[96:111], v[52:55], v[224:227], v[96:111]
    v_mfma_f32_32x32x16_bf16 v[112:127], v[56:59], v[224:227], v[112:127]
    buffer_load_dwordx4 v[212:215], v8, s[52:55], s83 offen offset:1024 sc1
    v_permlane32_swap_b32 v248, v250
    v_permlane32_swap_b32 v249, v251
    ds_read_b64_tr_b16 v[52:53], v148 offset:40960
    ds_read_b64_tr_b16 v[54:55], v148 offset:41984
    ds_read_b64_tr_b16 v[56:57], v149 offset:40960
    ds_read_b64_tr_b16 v[58:59], v149 offset:41984
    s_waitcnt vmcnt(7) lgkmcnt(8)
    v_mfma_f32_32x32x16_bf16 v[96:111], v[36:39], v[228:231], v[96:111]
    v_mfma_f32_32x32x16_bf16 v[112:127], v[40:43], v[228:231], v[112:127]
    s_lshr_b32 s83, s20, 4
    s_add_u32 s83, s83, s79
    buffer_load_dwordx4 v[216:219], v8, s[52:55], s83 offen offset:0 sc1
    v_lshlrev_b32 v128, 16, v248
    v_and_b32 v129, 0xffff0000, v248
    v_lshlrev_b32 v130, 16, v249
    v_and_b32 v131, 0xffff0000, v249
    v_lshlrev_b32 v132, 16, v250
    v_and_b32 v133, 0xffff0000, v250
    v_lshlrev_b32 v134, 16, v251
    v_and_b32 v135, 0xffff0000, v251
    s_barrier
    v_xor_b32 v2, 0, v157
    ds_read_b64_tr_b16 v[36:37], v150 offset:0
    ds_read_b64_tr_b16 v[38:39], v150 offset:1024
    ds_read_b64_tr_b16 v[40:41], v151 offset:0
    ds_read_b64_tr_b16 v[42:43], v151 offset:1024
    s_waitcnt vmcnt(7) lgkmcnt(8)
    v_mfma_f32_32x32x16_bf16 v[96:111], v[44:47], v[232:235], v[96:111]
    v_mfma_f32_32x32x16_bf16 v[112:127], v[48:51], v[232:235], v[112:127]
    ds_read_b64 v[64:65], v2
    ds_read_b64 v[66:67], v2 offset:8192
    buffer_load_dwordx4 v[220:223], v8, s[52:55], s83 offen offset:1024 sc1
    v_xor_b32 v2, 16, v157
    ds_read_b64_tr_b16 v[44:45], v150 offset:8192
    ds_read_b64_tr_b16 v[46:47], v150 offset:9216
    ds_read_b64_tr_b16 v[48:49], v151 offset:8192
    ds_read_b64_tr_b16 v[50:51], v151 offset:9216
    s_waitcnt vmcnt(7) lgkmcnt(10)
    v_mfma_f32_32x32x16_bf16 v[96:111], v[52:55], v[236:239], v[96:111]
    v_mfma_f32_32x32x16_bf16 v[112:127], v[56:59], v[236:239], v[112:127]
    ds_read_b64 v[68:69], v2
    ds_read_b64 v[70:71], v2 offset:8192
    s_lshr_b32 s83, s21, 4
    s_add_u32 s83, s83, s79
    buffer_load_dwordx4 v[224:227], v8, s[52:55], s83 offen offset:0 sc1
    v_xor_b32 v2, 32, v157
    ds_read_b64_tr_b16 v[52:53], v152 offset:0
    ds_read_b64_tr_b16 v[54:55], v152 offset:1024
    ds_read_b64_tr_b16 v[56:57], v153 offset:0
    ds_read_b64_tr_b16 v[58:59], v153 offset:1024
    s_waitcnt vmcnt(7) lgkmcnt(10)
    v_mfma_f32_32x32x16_bf16 v[96:111], v[36:39], v[240:243], v[96:111]
    v_mfma_f32_32x32x16_bf16 v[112:127], v[40:43], v[240:243], v[112:127]
    ds_read_b64 v[72:73], v2
    ds_read_b64 v[74:75], v2 offset:8192
    buffer_load_dwordx4 v[228:231], v8, s[52:55], s83 offen offset:1024 sc1
    v_swap_b32 v65, v66
    v_xor_b32 v2, 48, v157
    ds_read_b64_tr_b16 v[36:37], v152 offset:8192
    ds_read_b64_tr_b16 v[38:39], v152 offset:9216
    ds_read_b64_tr_b16 v[40:41], v153 offset:8192
    ds_read_b64_tr_b16 v[42:43], v153 offset:9216
    s_waitcnt vmcnt(7) lgkmcnt(10)
    v_mfma_f32_32x32x16_bf16 v[96:111], v[44:47], v[244:247], v[96:111]
    v_mfma_f32_32x32x16_bf16 v[112:127], v[48:51], v[244:247], v[112:127]
    ds_read_b64 v[76:77], v2
    ds_read_b64 v[78:79], v2 offset:8192
    s_lshr_b32 s83, s22, 4
    s_add_u32 s83, s83, s79
    buffer_load_dwordx4 v[232:235], v8, s[52:55], s83 offen offset:0 sc1
    v_swap_b32 v69, v70
    s_waitcnt vmcnt(6)
    v_cmp_ne_u32 vcc, 0, v3
    s_nop 0
    s_cmp_eq_u32 vcc_hi, -1
    s_cbranch_scc1 L_zpdF
L_zpF:
    s_sleep 12
    s_mov_b32 exec_lo, 0
    buffer_load_dword v3, v154, s[52:55], 0 offen sc1
    s_mov_b64 exec, -1
    s_waitcnt vmcnt(0)
    v_cmp_ne_u32 vcc, 0, v3
    s_nop 0
    s_cmp_eq_u32 vcc_hi, -1
    s_cbranch_scc1 L_zpdF
    s_add_u32 s84, s84, 1
    s_cmp_lt_u32 s84, 200000
    s_cbranch_scc1 L_zpF
L_zpdF:
    v_xor_b32 v2, 64, v157
    ds_read_b64_tr_b16 v[44:45], v152 offset:16384
    ds_read_b64_tr_b16 v[46:47], v152 offset:17408
    ds_read_b64_tr_b16 v[48:49], v153 offset:16384
    ds_read_b64_tr_b16 v[50:51], v153 offset:17408
    s_waitcnt vmcnt(7) lgkmcnt(10)
    v_mfma_f32_32x32x16_bf16 v[96:111], v[52:55], v[208:211], v[96:111]
    v_mfma_f32_32x32x16_bf16 v[112:127], v[56:59], v[208:211], v[112:127]
    ds_read_b64 v[80:81], v2
    ds_read_b64 v[82:83], v2 offset:8192
    buffer_load_dwordx4 v[236:239], v8, s[52:55], s83 offen offset:1024 sc1
    s_mov_b32 s10, 8388608
    buffer_load_dwordx4 v[160:163], v156, s[52:55], s10 offen sc1
    s_mov_b32 s10, 8407040
    buffer_load_dwordx4 v[164:167], v156, s[52:55], s10 offen sc1
    v_swap_b32 v73, v74
    v_xor_b32 v2, 80, v157
    ds_read_b64_tr_b16 v[52:53], v152 offset:24576
    ds_read_b64_tr_b16 v[54:55], v152 offset:25600
    ds_read_b64_tr_b16 v[56:57], v153 offset:24576
    ds_read_b64_tr_b16 v[58:59], v153 offset:25600
    s_waitcnt vmcnt(8) lgkmcnt(10)
    v_mfma_f32_32x32x16_bf16 v[96:111], v[36:39], v[212:215], v[96:111]
    v_mfma_f32_32x32x16_bf16 v[112:127], v[40:43], v[212:215], v[112:127]
    ds_read_b64 v[84:85], v2
    ds_read_b64 v[86:87], v2 offset:8192
    s_mov_b32 s10, 8425472
    buffer_load_dwordx4 v[168:171], v156, s[52:55], s10 offen sc1
    s_mov_b32 s10, 8443904
    buffer_load_dwordx4 v[172:175], v156, s[52:55], s10 offen sc1
    v_swap_b32 v77, v78
    v_xor_b32 v2, 96, v157
    ds_read_b64_tr_b16 v[36:37], v150 offset:16384
    ds_read_b64_tr_b16 v[38:39], v150 offset:17408
    ds_read_b64_tr_b16 v[40:41], v151 offset:16384
    ds_read_b64_tr_b16 v[42:43], v151 offset:17408
    s_waitcnt vmcnt(9) lgkmcnt(10)
    v_mfma_f32_32x32x16_bf16 v[96:111], v[44:47], v[216:219], v[96:111]
    v_mfma_f32_32x32x16_bf16 v[112:127], v[48:51], v[216:219], v[112:127]
    ds_read_b64 v[88:89], v2
    ds_read_b64 v[90:91], v2 offset:8192
    s_mov_b32 s10, 8462336
    buffer_load_dwordx4 v[176:179], v156, s[52:55], s10 offen sc1
    s_mov_b32 s10, 8480768
    buffer_load_dwordx4 v[180:183], v156, s[52:55], s10 offen sc1
    v_swap_b32 v81, v82
    v_xor_b32 v2, 112, v157
    ds_read_b64_tr_b16 v[44:45], v150 offset:24576
    ds_read_b64_tr_b16 v[46:47], v150 offset:25600
    ds_read_b64_tr_b16 v[48:49], v151 offset:24576
    ds_read_b64_tr_b16 v[50:51], v151 offset:25600
    s_waitcnt vmcnt(10) lgkmcnt(10)
    v_mfma_f32_32x32x16_bf16 v[96:111], v[52:55], v[220:223], v[96:111]
    v_mfma_f32_32x32x16_bf16 v[112:127], v[56:59], v[220:223], v[112:127]
    ds_read_b64 v[92:93], v2
    ds_read_b64 v[94:95], v2 offset:8192
    s_mov_b32 s10, 8499200
    buffer_load_dwordx4 v[184:187], v156, s[52:55], s10 offen sc1
    s_mov_b32 s10, 8517632
    buffer_load_dwordx4 v[188:191], v156, s[52:55], s10 offen sc1
    v_swap_b32 v85, v86
    ds_read_b64_tr_b16 v[52:53], v150 offset:32768
    ds_read_b64_tr_b16 v[54:55], v150 offset:33792
    ds_read_b64_tr_b16 v[56:57], v151 offset:32768
    ds_read_b64_tr_b16 v[58:59], v151 offset:33792
    s_waitcnt vmcnt(11) lgkmcnt(10)
    v_mfma_f32_32x32x16_bf16 v[96:111], v[36:39], v[224:227], v[96:111]
    v_mfma_f32_32x32x16_bf16 v[112:127], v[40:43], v[224:227], v[112:127]
    v_swap_b32 v89, v90
    ds_read_b64_tr_b16 v[36:37], v150 offset:40960
    ds_read_b64_tr_b16 v[38:39], v150 offset:41984
    ds_read_b64_tr_b16 v[40:41], v151 offset:40960
    ds_read_b64_tr_b16 v[42:43], v151 offset:41984
    s_waitcnt vmcnt(10) lgkmcnt(8)
    v_mfma_f32_32x32x16_bf16 v[96:111], v[44:47], v[228:231], v[96:111]
    v_mfma_f32_32x32x16_bf16 v[112:127], v[48:51], v[228:231], v[112:127]
    v_swap_b32 v93, v94
    s_waitcnt vmcnt(9) lgkmcnt(4)
    v_mfma_f32_32x32x16_bf16 v[96:111], v[52:55], v[232:235], v[96:111]
    v_mfma_f32_32x32x16_bf16 v[112:127], v[56:59], v[232:235], v[112:127]
    s_waitcnt vmcnt(8) lgkmcnt(0)
    v_mfma_f32_32x32x16_bf16 v[96:111], v[36:39], v[236:239], v[96:111]
    v_mfma_f32_32x32x16_bf16 v[112:127], v[40:43], v[236:239], v[112:127]
    s_nop 10
    ds_write_b128 v16, v[104:107] offset:49152
    ds_write_b128 v16, v[108:111] offset:57344
    ds_write_b128 v17, v[112:115] offset:49152
    ds_write_b128 v17, v[116:119] offset:57344
    ds_write_b128 v18, v[120:123] offset:16384
    ds_write_b128 v18, v[124:127] offset:24576
    s_waitcnt lgkmcnt(0)
    s_barrier
    ds_read_b128 v[104:107], v19 offset:49152
    ds_read_b128 v[108:111], v19 offset:57344
    ds_read_b128 v[112:115], v24 offset:49152
    ds_read_b128 v[116:119], v24 offset:57344
    ds_read_b128 v[120:123], v25 offset:16384
    ds_read_b128 v[124:127], v25 offset:24576
    s_waitcnt vmcnt(4)
    v_permlane16_swap_b32 v160, v162
    v_permlane16_swap_b32 v161, v163
    v_permlane16_swap_b32 v164, v166
    v_permlane16_swap_b32 v165, v167
    v_permlane16_swap_b32 v168, v170
    v_permlane16_swap_b32 v169, v171
    v_permlane16_swap_b32 v172, v174
    v_permlane16_swap_b32 v173, v175
    v_mfma_f32_32x32x16_bf16 v[192:207], v[160:163], v[64:67], 0
    v_mfma_f32_32x32x16_bf16 v[192:207], v[164:167], v[68:71], v[192:207]
    v_mfma_f32_32x32x16_bf16 v[192:207], v[168:171], v[72:75], v[192:207]
    v_mfma_f32_32x32x16_bf16 v[192:207], v[172:175], v[76:79], v[192:207]
    s_waitcnt lgkmcnt(4)
    v_add_f32 v96, v96, v104
    v_add_f32 v97, v97, v105
    v_add_f32 v98, v98, v106
    v_add_f32 v99, v99, v107
    v_add_f32 v100, v100, v108
    v_add_f32 v101, v101, v109
    v_add_f32 v102, v102, v110
    v_add_f32 v103, v103, v111
    s_waitcnt lgkmcnt(0)
    v_add_f32 v112, v112, v120
    v_add_f32 v113, v113, v121
    v_add_f32 v114, v114, v122
    v_add_f32 v115, v115, v123
    v_add_f32 v116, v116, v124
    v_add_f32 v117, v117, v125
    v_add_f32 v118, v118, v126
    v_add_f32 v119, v119, v127
    v_add_f32 v96, v96, v112
    v_add_f32 v97, v97, v113
    v_add_f32 v98, v98, v114
    v_add_f32 v99, v99, v115
    v_add_f32 v100, v100, v116
    v_add_f32 v101, v101, v117
    v_add_f32 v102, v102, v118
    v_add_f32 v103, v103, v119
    s_waitcnt vmcnt(0)
    v_permlane16_swap_b32 v176, v178
    v_permlane16_swap_b32 v177, v179
    v_permlane16_swap_b32 v180, v182
    v_permlane16_swap_b32 v181, v183
    v_permlane16_swap_b32 v184, v186
    v_permlane16_swap_b32 v185, v187
    v_permlane16_swap_b32 v188, v190
    v_permlane16_swap_b32 v189, v191
    v_mfma_f32_32x32x16_bf16 v[192:207], v[176:179], v[80:83], v[192:207]
    v_mfma_f32_32x32x16_bf16 v[192:207], v[180:183], v[84:87], v[192:207]
    v_mfma_f32_32x32x16_bf16 v[192:207], v[184:187], v[88:91], v[192:207]
    v_mfma_f32_32x32x16_bf16 v[192:207], v[188:191], v[92:95], v[192:207]
    v_mul_f32 v136, 0xbfb8aa3b, v96
    v_mul_f32 v137, 0xbfb8aa3b, v97
    v_mul_f32 v138, 0xbfb8aa3b, v98
    v_mul_f32 v139, 0xbfb8aa3b, v99
    v_mul_f32 v140, 0xbfb8aa3b, v100
    v_mul_f32 v141, 0xbfb8aa3b, v101
    v_mul_f32 v142, 0xbfb8aa3b, v102
    v_mul_f32 v143, 0xbfb8aa3b, v103
    v_exp_f32 v136, v136
    v_exp_f32 v137, v137
    v_exp_f32 v138, v138
    v_exp_f32 v139, v139
    v_exp_f32 v140, v140
    v_exp_f32 v141, v141
    v_exp_f32 v142, v142
    v_exp_f32 v143, v143
    v_add_f32 v136, 1.0, v136
    v_add_f32 v137, 1.0, v137
    v_add_f32 v138, 1.0, v138
    v_add_f32 v139, 1.0, v139
    v_add_f32 v140, 1.0, v140
    v_add_f32 v141, 1.0, v141
    v_add_f32 v142, 1.0, v142
    v_add_f32 v143, 1.0, v143
    v_rcp_f32 v136, v136
    v_rcp_f32 v137, v137
    v_rcp_f32 v138, v138
    v_rcp_f32 v139, v139
    v_rcp_f32 v140, v140
    v_rcp_f32 v141, v141
    v_rcp_f32 v142, v142
    v_rcp_f32 v143, v143
    v_mul_f32 v136, v136, v96
    v_mul_f32 v137, v137, v97
    v_mul_f32 v138, v138, v98
    v_mul_f32 v139, v139, v99
    v_mul_f32 v140, v140, v100
    v_mul_f32 v141, v141, v101
    v_mul_f32 v142, v142, v102
    v_mul_f32 v143, v143, v103
    v_fma_f32 v128, v192, v136, v128
    v_fma_f32 v129, v193, v137, v129
    v_fma_f32 v130, v194, v138, v130
    v_fma_f32 v131, v195, v139, v131
    v_fma_f32 v132, v196, v140, v132
    v_fma_f32 v133, v197, v141, v133
    v_fma_f32 v134, v198, v142, v134
    v_fma_f32 v135, v199, v143, v135
    v_cvt_pk_bf16_f32 v248, v128, v129
    v_cvt_pk_bf16_f32 v249, v130, v131
    v_cvt_pk_bf16_f32 v250, v132, v133
    v_cvt_pk_bf16_f32 v251, v134, v135
    s_nop 0
    v_permlane32_swap_b32 v248, v250
    v_permlane32_swap_b32 v249, v251
    buffer_store_dwordx4 v[248:251], v155, s[68:71], 0 offen
    s_endpgm
L_dft:
    s_sub_u32 s12, s7, 14
    s_lshl_b32 s12, s12, 7
    s_lshl_b32 s11, s3, 4
    s_add_u32 s11, s11, s12
    v_add_u32 v7, s11, v2
    v_lshl_add_u32 v12, v7, 10, v4
    v_xor_b32 v13, 64, v12
    v_add_u32 v13, 8192, v13
    s_waitcnt lgkmcnt(0)
    s_mov_b32 s40, s16
    s_mov_b32 s41, s17
    s_mov_b32 s42, 0x200000
    s_mov_b32 s43, 0x00020000
    s_mov_b32 s44, s22
    s_mov_b32 s45, s23
    s_mov_b32 s46, 0x80000
    s_mov_b32 s47, 0x00020000
    s_mov_b32 s48, s24
    s_mov_b32 s49, s25
    s_mov_b32 s50, 0x80000
    s_mov_b32 s51, 0x00020000
    s_add_u32 s12, s22, 0x40000
    s_addc_u32 s13, s23, 0
    v_cmp_eq_u32 vcc, 0, v7
    v_mov_b32 v14, s24
    v_mov_b32 v15, s25
    v_mov_b32 v5, s12
    v_mov_b32 v6, s13
    v_cndmask_b32 v14, v14, v5, vcc
    v_cndmask_b32 v15, v15, v6, vcc
    v_add_co_u32 v14, vcc, v14, v12
    s_nop 1
    v_addc_co_u32 v15, vcc, 0, v15, vcc
    s_add_u32 m0, s8, 12288
    s_nop 0
    buffer_load_dwordx4 v8, s[40:43], s76 offen lds
    s_add_u32 m0, s8, 13312
    s_nop 0
    buffer_load_dwordx4 v9, s[40:43], s76 offen lds
    s_add_u32 m0, s8, 61440
    s_nop 0
    buffer_load_dwordx4 v12, s[44:47], s76 offen lds
    s_add_u32 m0, s8, 62464
    s_nop 0
    buffer_load_dwordx4 v13, s[44:47], s76 offen lds
    v_add_co_u32 v10, vcc, s76, v14
    s_add_u32 m0, s8, 77824
    s_nop 0
    v_addc_co_u32 v11, vcc, 0, v15, vcc
    global_load_lds_dwordx4 v[10:11], off
    s_add_u32 m0, s8, 78848
    s_nop 0
    buffer_load_dwordx4 v13, s[48:51], s76 offen lds
    v_and_b32 v5, 31, v1
    v_lshrrev_b32 v6, 5, v1
    v_bfe_u32 v7, v1, 1, 3
    v_xor_b32 v7, v7, v6
    s_lshl_b32 s11, s4, 13
    s_add_u32 s11, s11, 12288
    v_lshl_add_u32 v2, v5, 7, s11
    s_xor_b32 s12, s5, 0
    s_lshl_b32 s12, s12, 1
    v_xor_b32 v3, s12, v7
    v_lshl_add_u32 v20, v3, 4, v2
    s_xor_b32 s12, s5, 1
    s_lshl_b32 s12, s12, 1
    v_xor_b32 v3, s12, v7
    v_lshl_add_u32 v21, v3, 4, v2
    s_xor_b32 s12, s5, 2
    s_lshl_b32 s12, s12, 1
    v_xor_b32 v3, s12, v7
    v_lshl_add_u32 v22, v3, 4, v2
    s_xor_b32 s12, s5, 3
    s_lshl_b32 s12, s12, 1
    v_xor_b32 v3, s12, v7
    v_lshl_add_u32 v23, v3, 4, v2
    s_lshl_b32 s11, s5, 12
    s_lshl_b32 s12, s4, 13
    s_sub_u32 s11, s11, s12
    s_add_u32 s11, s11, 49152
    v_add_u32 v24, s11, v20
    v_add_u32 v28, 0x10000, v24
    v_add_u32 v25, s11, v21
    v_add_u32 v29, 0x10000, v25
    v_add_u32 v26, s11, v22
    v_add_u32 v30, 0x10000, v26
    v_add_u32 v27, s11, v23
    v_add_u32 v31, 0x10000, v27
    v_mov_b32 v32, 0
    v_mov_b32 v33, 0
    v_mov_b32 v34, 0
    v_mov_b32 v35, 0
    v_mov_b32 v36, 0
    v_mov_b32 v37, 0
    v_mov_b32 v38, 0
    v_mov_b32 v39, 0
    v_mov_b32 v88, 0
    v_mov_b32 v89, 0
    v_mov_b32 v90, 0
    v_mov_b32 v91, 0
    v_mov_b32 v92, 0
    v_mov_b32 v93, 0
    v_mov_b32 v94, 0
    v_mov_b32 v95, 0
    v_mov_b32 v96, 0
    v_mov_b32 v97, 0
    v_mov_b32 v98, 0
    v_mov_b32 v99, 0
    s_mov_b32 s52, s38
    s_mov_b32 s53, s39
    s_mov_b32 s54, 0x1000000
    s_mov_b32 s55, 0x00020000
    s_mov_b32 s56, s18
    s_mov_b32 s57, s19
    s_mov_b32 s58, 0x800000
    s_mov_b32 s59, 0x00020000
    s_mov_b32 s60, s20
    s_mov_b32 s61, s21
    s_mov_b32 s62, 0x800000
    s_mov_b32 s63, 0x00020000
    s_mov_b32 s64, s32
    s_mov_b32 s65, s33
    s_mov_b32 s66, 0x1c0000
    s_mov_b32 s67, 0x00020000
    s_mov_b32 s68, s34
    s_mov_b32 s69, s35
    s_mov_b32 s70, 0x200000
    s_mov_b32 s71, 0x00020000
    s_mov_b32 s72, s36
    s_mov_b32 s73, s37
    s_mov_b32 s74, 0x100
    s_mov_b32 s75, 0x00020000
    s_and_b32 s15, s2, 7
    s_lshl_b32 s10, s15, 2
    s_lshr_b32 s28, s2, 3
    s_and_b32 s11, s28, 3
    s_add_u32 s10, s10, s11
    s_lshr_b32 s28, s28, 2
    s_lshl_b32 s11, s11, 1
    s_add_u32 s11, s28, s11
    s_lshr_b32 s12, s10, 1
    s_sub_u32 s13, 32, s12
    s_cmp_eq_u32 s12, 0
    s_cselect_b32 s13, 16, s13
    s_bitcmp1_b32 s10, 0
    s_cselect_b32 s12, s13, s12
    s_lshl_b32 s23, s4, 5
    s_add_u32 s23, s23, s12
    s_lshr_b32 s24, s28, 2
    s_sub_u32 s25, 0, s24
    s_mul_i32 s81, s23, 114688
    s_add_u32 s79, s81, 4096
    s_lshl_b32 s80, s5, 11
    s_lshl_b32 s15, s4, 10
    s_add_u32 s80, s80, s15
    s_lshl_b32 s85, s5, 10
    s_lshl_b32 s15, s4, 12
    s_add_u32 s85, s85, s15
    s_lshl_b32 s26, s28, 6
    s_lshl_b32 s15, s5, 4
    s_add_u32 s26, s26, s15
    s_cmp_lt_u32 s10, 2
    s_cselect_b32 s15, 0, s24
    s_xor_b32 s10, s10, s15
    s_and_b32 s15, s10, 1
    s_lshl_b32 s15, s15, 3
    s_lshr_b32 s10, s10, 1
    s_mul_i32 s27, s10, 147456
    s_add_u32 s27, s27, s15
    s_mul_i32 s15, s5, 7
    s_lshr_b32 s15, s15, 1
    s_lshl_b32 s82, 15, s15
    s_lshl_b32 s10, s7, 7
    s_lshl_b32 s15, s6, 2
    s_add_u32 s10, s10, s15
    s_add_u32 s10, s10, 12582912
    s_cmp_eq_u32 s3, 0
    s_cselect_b32 s30, s10, -1
    s_mov_b32 s10, s11
    s_and_b32 s11, s2, 7
    s_add_u32 s10, s10, s11
    s_cmp_ge_u32 s10, 14
    s_cselect_b32 s11, 14, 0
    s_sub_u32 s10, s10, s11
    s_cmp_ge_u32 s10, 7
    s_cselect_b32 s11, 7, 0
    s_sub_u32 s10, s10, s11
    s_mul_i32 s11, s5, 14
    s_lshl_b32 s12, s10, 1
    s_add_u32 s12, s12, s11
    s_andn2_b32 s13, s12, 3
    s_add_u32 s12, s12, s13
    s_lshl_b32 s16, s12, 14
    s_add_u32 s10, s10, 1
    s_cmp_eq_u32 s10, 7
    s_cselect_b32 s10, 0, s10
    s_lshl_b32 s12, s10, 1
    s_add_u32 s12, s12, s11
    s_andn2_b32 s13, s12, 3
    s_add_u32 s12, s12, s13
    s_lshl_b32 s17, s12, 14
    s_add_u32 s10, s10, 1
    s_cmp_eq_u32 s10, 7
    s_cselect_b32 s10, 0, s10
    s_lshl_b32 s12, s10, 1
    s_add_u32 s12, s12, s11
    s_andn2_b32 s13, s12, 3
    s_add_u32 s12, s12, s13
    s_lshl_b32 s18, s12, 14
    s_add_u32 s10, s10, 1
    s_cmp_eq_u32 s10, 7
    s_cselect_b32 s10, 0, s10
    s_lshl_b32 s12, s10, 1
    s_add_u32 s12, s12, s11
    s_andn2_b32 s13, s12, 3
    s_add_u32 s12, s12, s13
    s_lshl_b32 s19, s12, 14
    s_add_u32 s10, s10, 1
    s_cmp_eq_u32 s10, 7
    s_cselect_b32 s10, 0, s10
    s_lshl_b32 s12, s10, 1
    s_add_u32 s12, s12, s11
    s_andn2_b32 s13, s12, 3
    s_add_u32 s12, s12, s13
    s_lshl_b32 s20, s12, 14
    s_add_u32 s10, s10, 1
    s_cmp_eq_u32 s10, 7
    s_cselect_b32 s10, 0, s10
    s_lshl_b32 s12, s10, 1
    s_add_u32 s12, s12, s11
    s_andn2_b32 s13, s12, 3
    s_add_u32 s12, s12, s13
    s_lshl_b32 s21, s12, 14
    s_add_u32 s10, s10, 1
    s_cmp_eq_u32 s10, 7
    s_cselect_b32 s10, 0, s10
    s_lshl_b32 s12, s10, 1
    s_add_u32 s12, s12, s11
    s_andn2_b32 s13, s12, 3
    s_add_u32 s12, s12, s13
    s_lshl_b32 s22, s12, 14
    s_add_u32 s10, s10, 1
    s_cmp_eq_u32 s10, 7
    s_cselect_b32 s10, 0, s10
    v_and_b32 v2, 31, v1
    v_lshlrev_b32 v2, 1, v2
    s_mov_b32 s13, 262144
    buffer_load_ushort v184, v2, s[56:59], s13 offen
    buffer_load_ushort v185, v2, s[60:63], s13 offen
    s_sub_u32 s10, s7, 14
    s_add_u32 s10, s10, s6
    s_lshl_b32 s10, s10, 9
    v_add_u32 v18, s10, v0
    v_lshlrev_b32 v5, 7, v18
    v_and_b32 v3, 15, v1
    v_lshlrev_b32 v3, 2, v3
    v_bfe_u32 v4, v1, 4, 1
    v_lshl_add_u32 v3, v4, 7, v3
    v_add_u32 v3, 1792, v3
    v_cmp_gt_u32 vcc, 0x100, v18
    s_nop 1
    v_cndmask_b32 v5, v3, v5, vcc
    v_add_u32 v5, 12582912, v5
    v_cmp_gt_u32 vcc, 0x140, v18
    s_nop 1
    v_cndmask_b32 v5, -1, v5, vcc
    v_lshlrev_b32 v18, 8, v18
    s_add_u32 s76, s76, 128
    s_and_b32 s76, s76, 0x3ff
    s_add_u32 m0, s8, 28672
    s_nop 0
    buffer_load_dwordx4 v8, s[40:43], s76 offen lds
    s_add_u32 m0, s8, 29696
    s_nop 0
    buffer_load_dwordx4 v9, s[40:43], s76 offen lds
    s_add_u32 m0, s8, 94208
    s_nop 0
    buffer_load_dwordx4 v12, s[44:47], s76 offen lds
    s_add_u32 m0, s8, 95232
    s_nop 0
    buffer_load_dwordx4 v13, s[44:47], s76 offen lds
    v_add_co_u32 v10, vcc, s76, v14
    s_add_u32 m0, s8, 110592
    s_nop 0
    v_addc_co_u32 v11, vcc, 0, v15, vcc
    global_load_lds_dwordx4 v[10:11], off
    s_add_u32 m0, s8, 111616
    s_nop 0
    buffer_load_dwordx4 v13, s[48:51], s76 offen lds
    buffer_store_dword v32, v5, s[52:55], 0 offen sc1
    s_waitcnt vmcnt(9)
    s_barrier
    ds_read_b128 v[40:43], v20 offset:0
    ds_read_b128 v[48:51], v24 offset:0
    ds_read_b128 v[52:55], v24 offset:16384
    ds_read_b128 v[44:47], v20 offset:4096
    ds_read_b128 v[56:59], v21 offset:0
    ds_read_b128 v[64:67], v25 offset:0
    ds_read_b128 v[68:71], v25 offset:16384
    ds_read_b128 v[60:63], v21 offset:4096
    s_waitcnt lgkmcnt(4)
    v_mfma_f32_32x32x16_bf16 v[120:135], v[40:43], v[48:51], 0
    ds_read_b128 v[72:75], v22 offset:0
    ds_read_b128 v[80:83], v26 offset:0
    v_lshlrev_b32 v4, 16, v40
    v_and_b32 v5, 0xffff0000, v40
    v_add_f32 v32, v32, v4
    v_mfma_f32_32x32x16_bf16 v[136:151], v[40:43], v[52:55], 0
    ds_read_b128 v[84:87], v26 offset:16384
    ds_read_b128 v[76:79], v22 offset:4096
    v_fmac_f32 v34, v4, v4
    v_add_f32 v36, v36, v5
    v_fmac_f32 v38, v5, v5
    v_mfma_f32_32x32x16_bf16 v[152:167], v[44:47], v[48:51], 0
    v_lshlrev_b32 v6, 16, v41
    v_and_b32 v7, 0xffff0000, v41
    v_add_f32 v32, v32, v6
    v_mfma_f32_32x32x16_bf16 v[168:183], v[44:47], v[52:55], 0
    v_fmac_f32 v34, v6, v6
    v_add_f32 v36, v36, v7
    v_fmac_f32 v38, v7, v7
    s_waitcnt lgkmcnt(4)
    v_mfma_f32_32x32x16_bf16 v[120:135], v[56:59], v[64:67], v[120:135]
    ds_read_b128 v[40:43], v23 offset:0
    ds_read_b128 v[48:51], v27 offset:0
    v_lshlrev_b32 v4, 16, v60
    v_and_b32 v5, 0xffff0000, v60
    v_add_f32 v33, v33, v4
    v_mfma_f32_32x32x16_bf16 v[136:151], v[56:59], v[68:71], v[136:151]
    ds_read_b128 v[52:55], v27 offset:16384
    ds_read_b128 v[44:47], v23 offset:4096
    v_fmac_f32 v35, v4, v4
    v_add_f32 v37, v37, v5
    v_fmac_f32 v39, v5, v5
    v_mfma_f32_32x32x16_bf16 v[152:167], v[60:63], v[64:67], v[152:167]
    v_lshlrev_b32 v6, 16, v61
    v_and_b32 v7, 0xffff0000, v61
    v_add_f32 v33, v33, v6
    v_mfma_f32_32x32x16_bf16 v[168:183], v[60:63], v[68:71], v[168:183]
    v_fmac_f32 v35, v6, v6
    v_add_f32 v37, v37, v7
    v_fmac_f32 v39, v7, v7
    s_waitcnt vmcnt(7)
    v_lshl_or_b32 v184, v185, 16, v184
    v_bfe_u32 v2, v1, 1, 4
    v_sub_u32 v3, 32, v2
    s_mov_b32 vcc_lo, 0xaaaaaaa8
    s_mov_b32 vcc_hi, 0xaaaaaaa8
    v_cndmask_b32 v2, v2, v3, vcc
    s_mov_b32 vcc_lo, 2
    s_mov_b32 vcc_hi, 2
    v_cndmask_b32 v2, v2, 16, vcc
    v_lshlrev_b32 v2, 2, v2
    v_lshrrev_b32 v3, 5, v1
    v_lshlrev_b32 v3, 2, v3
    v_mul_u32_u24 v3, v2, v3
    s_waitcnt lgkmcnt(0)
    v_mad_u32_u24 v186, v2, 0, v3
    v_and_b32 v186, 124, v186
    ds_bpermute_b32 v186, v186, v184
    v_mad_u32_u24 v187, v2, 1, v3
    v_and_b32 v187, 124, v187
    ds_bpermute_b32 v187, v187, v184
    v_mad_u32_u24 v188, v2, 2, v3
    v_and_b32 v188, 124, v188
    ds_bpermute_b32 v188, v188, v184
    v_mad_u32_u24 v189, v2, 3, v3
    v_and_b32 v189, 124, v189
    ds_bpermute_b32 v189, v189, v184
    v_mad_u32_u24 v190, v2, 8, v3
    v_and_b32 v190, 124, v190
    ds_bpermute_b32 v190, v190, v184
    v_mad_u32_u24 v191, v2, 9, v3
    v_and_b32 v191, 124, v191
    ds_bpermute_b32 v191, v191, v184
    v_mad_u32_u24 v192, v2, 10, v3
    v_and_b32 v192, 124, v192
    ds_bpermute_b32 v192, v192, v184
    v_mad_u32_u24 v193, v2, 11, v3
    v_and_b32 v193, 124, v193
    ds_bpermute_b32 v193, v193, v184
    v_mad_u32_u24 v194, v2, 16, v3
    v_and_b32 v194, 124, v194
    ds_bpermute_b32 v194, v194, v184
    v_mad_u32_u24 v195, v2, 17, v3
    v_and_b32 v195, 124, v195
    ds_bpermute_b32 v195, v195, v184
    v_mad_u32_u24 v196, v2, 18, v3
    v_and_b32 v196, 124, v196
    ds_bpermute_b32 v196, v196, v184
    v_mad_u32_u24 v197, v2, 19, v3
    v_and_b32 v197, 124, v197
    ds_bpermute_b32 v197, v197, v184
    s_waitcnt lgkmcnt(4)
    v_mad_u32_u24 v198, v2, 24, v3
    v_and_b32 v198, 124, v198
    ds_bpermute_b32 v198, v198, v184
    v_mad_u32_u24 v199, v2, 25, v3
    v_and_b32 v199, 124, v199
    ds_bpermute_b32 v199, v199, v184
    v_mad_u32_u24 v200, v2, 26, v3
    v_and_b32 v200, 124, v200
    ds_bpermute_b32 v200, v200, v184
    v_mad_u32_u24 v201, v2, 27, v3
    v_and_b32 v201, 124, v201
    ds_bpermute_b32 v201, v201, v184
    s_mov_b32 s13, 0x05040100
    s_mov_b32 s14, 0x07060302
    s_mov_b32 s15, 0x80008000
    s_waitcnt lgkmcnt(0)
    v_perm_b32 v104, v187, v186, s13
    v_perm_b32 v112, v187, v186, s14
    v_perm_b32 v105, v189, v188, s13
    v_perm_b32 v113, v189, v188, s14
    v_perm_b32 v106, v191, v190, s13
    v_perm_b32 v114, v191, v190, s14
    v_perm_b32 v107, v193, v192, s13
    v_perm_b32 v115, v193, v192, s14
    v_perm_b32 v108, v195, v194, s13
    v_perm_b32 v116, v195, v194, s14
    v_perm_b32 v109, v197, v196, s13
    v_perm_b32 v117, v197, v196, s14
    v_perm_b32 v110, v199, v198, s13
    v_perm_b32 v118, v199, v198, s14
    v_perm_b32 v111, v201, v200, s13
    v_perm_b32 v119, v201, v200, s14
    v_xor_b32 v112, s15, v112
    v_xor_b32 v113, s15, v113
    v_xor_b32 v114, s15, v114
    v_xor_b32 v115, s15, v115
    v_xor_b32 v116, s15, v116
    v_xor_b32 v117, s15, v117
    v_xor_b32 v118, s15, v118
    v_xor_b32 v119, s15, v119
    s_add_u32 s76, s76, 128
    s_and_b32 s76, s76, 0x3ff
    s_add_u32 m0, s8, 45056
    s_nop 0
    buffer_load_dwordx4 v8, s[40:43], s76 offen lds
    s_add_u32 m0, s8, 46080
    s_nop 0
    buffer_load_dwordx4 v9, s[40:43], s76 offen lds
    s_add_u32 m0, s8, 126976
    s_nop 0
    buffer_load_dwordx4 v12, s[44:47], s76 offen lds
    s_add_u32 m0, s8, 128000
    s_nop 0
    buffer_load_dwordx4 v13, s[44:47], s76 offen lds
    v_add_co_u32 v10, vcc, s76, v14
    s_add_u32 m0, s8, 143360
    s_nop 0
    v_addc_co_u32 v11, vcc, 0, v15, vcc
    global_load_lds_dwordx4 v[10:11], off
    s_add_u32 m0, s8, 144384
    s_nop 0
    buffer_load_dwordx4 v13, s[48:51], s76 offen lds
    s_waitcnt vmcnt(7) lgkmcnt(0)
    s_barrier
    v_mfma_f32_32x32x16_bf16 v[120:135], v[72:75], v[80:83], v[120:135]
    ds_read_b128 v[56:59], v20 offset:16384
    ds_read_b128 v[64:67], v24 offset:32768
    v_lshlrev_b32 v4, 16, v74
    v_and_b32 v5, 0xffff0000, v74
    v_add_f32 v32, v32, v4
    v_mfma_f32_32x32x16_bf16 v[136:151], v[72:75], v[84:87], v[136:151]
    ds_read_b128 v[68:71], v24 offset:49152
    ds_read_b128 v[60:63], v20 offset:20480
    v_fmac_f32 v34, v4, v4
    v_add_f32 v36, v36, v5
    v_fmac_f32 v38, v5, v5
    v_mfma_f32_32x32x16_bf16 v[152:167], v[76:79], v[80:83], v[152:167]
    s_add_u32 s76, s76, 128
    s_and_b32 s76, s76, 0x3ff
    s_add_u32 m0, s8, 12288
    s_nop 0
    buffer_load_dwordx4 v8, s[40:43], s76 offen lds
    v_lshlrev_b32 v6, 16, v75
    v_and_b32 v7, 0xffff0000, v75
    v_add_f32 v32, v32, v6
    v_mfma_f32_32x32x16_bf16 v[168:183], v[76:79], v[84:87], v[168:183]
    s_add_u32 m0, s8, 13312
    s_nop 0
    buffer_load_dwordx4 v9, s[40:43], s76 offen lds
    v_fmac_f32 v34, v6, v6
    v_add_f32 v36, v36, v7
    v_fmac_f32 v38, v7, v7
    s_waitcnt lgkmcnt(15)
    v_mfma_f32_32x32x16_bf16 v[120:135], v[40:43], v[48:51], v[120:135]
    ds_read_b128 v[72:75], v21 offset:16384
    ds_read_b128 v[80:83], v25 offset:32768
    v_lshlrev_b32 v4, 16, v46
    v_and_b32 v5, 0xffff0000, v46
    v_add_f32 v33, v33, v4
    v_mfma_f32_32x32x16_bf16 v[136:151], v[40:43], v[52:55], v[136:151]
    ds_read_b128 v[84:87], v25 offset:49152
    ds_read_b128 v[76:79], v21 offset:20480
    v_fmac_f32 v35, v4, v4
    v_add_f32 v37, v37, v5
    v_fmac_f32 v39, v5, v5
    v_mfma_f32_32x32x16_bf16 v[152:167], v[44:47], v[48:51], v[152:167]
    s_add_u32 m0, s8, 61440
    s_nop 0
    buffer_load_dwordx4 v12, s[44:47], s76 offen lds
    v_lshlrev_b32 v6, 16, v47
    v_and_b32 v7, 0xffff0000, v47
    v_add_f32 v33, v33, v6
    v_mfma_f32_32x32x16_bf16 v[168:183], v[44:47], v[52:55], v[168:183]
    v_fmac_f32 v35, v6, v6
    v_add_f32 v37, v37, v7
    v_fmac_f32 v39, v7, v7
    s_waitcnt lgkmcnt(4)
    v_mfma_f32_32x32x16_bf16 v[120:135], v[56:59], v[64:67], v[120:135]
    ds_read_b128 v[40:43], v22 offset:16384
    ds_read_b128 v[48:51], v26 offset:32768
    v_lshlrev_b32 v4, 16, v56
    v_and_b32 v5, 0xffff0000, v56
    v_add_f32 v32, v32, v4
    v_mfma_f32_32x32x16_bf16 v[136:151], v[56:59], v[68:71], v[136:151]
    ds_read_b128 v[52:55], v26 offset:49152
    ds_read_b128 v[44:47], v22 offset:20480
    v_fmac_f32 v34, v4, v4
    v_add_f32 v36, v36, v5
    v_fmac_f32 v38, v5, v5
    v_mfma_f32_32x32x16_bf16 v[152:167], v[60:63], v[64:67], v[152:167]
    s_add_u32 m0, s8, 62464
    s_nop 0
    buffer_load_dwordx4 v13, s[44:47], s76 offen lds
    v_lshlrev_b32 v6, 16, v57
    v_and_b32 v7, 0xffff0000, v57
    v_add_f32 v32, v32, v6
    v_mfma_f32_32x32x16_bf16 v[168:183], v[60:63], v[68:71], v[168:183]
    v_add_co_u32 v10, vcc, s76, v14
    s_add_u32 m0, s8, 77824
    s_nop 0
    v_addc_co_u32 v11, vcc, 0, v15, vcc
    global_load_lds_dwordx4 v[10:11], off
    v_fmac_f32 v34, v6, v6
    v_add_f32 v36, v36, v7
    v_fmac_f32 v38, v7, v7
    s_waitcnt lgkmcnt(4)
    v_mfma_f32_32x32x16_bf16 v[120:135], v[72:75], v[80:83], v[120:135]
    ds_read_b128 v[56:59], v23 offset:16384
    ds_read_b128 v[64:67], v27 offset:32768
    v_lshlrev_b32 v4, 16, v76
    v_and_b32 v5, 0xffff0000, v76
    v_add_f32 v33, v33, v4
    v_mfma_f32_32x32x16_bf16 v[136:151], v[72:75], v[84:87], v[136:151]
    ds_read_b128 v[68:71], v27 offset:49152
    ds_read_b128 v[60:63], v23 offset:20480
    v_fmac_f32 v35, v4, v4
    v_add_f32 v37, v37, v5
    v_fmac_f32 v39, v5, v5
    v_mfma_f32_32x32x16_bf16 v[152:167], v[76:79], v[80:83], v[152:167]
    s_add_u32 m0, s8, 78848
    s_nop 0
    buffer_load_dwordx4 v13, s[48:51], s76 offen lds
    v_lshlrev_b32 v6, 16, v77
    v_and_b32 v7, 0xffff0000, v77
    v_add_f32 v33, v33, v6
    v_mfma_f32_32x32x16_bf16 v[168:183], v[76:79], v[84:87], v[168:183]
    v_fmac_f32 v35, v6, v6
    v_add_f32 v37, v37, v7
    v_fmac_f32 v39, v7, v7
    s_waitcnt vmcnt(6) lgkmcnt(0)
    s_barrier
    v_mfma_f32_32x32x16_bf16 v[120:135], v[40:43], v[48:51], v[120:135]
    ds_read_b128 v[72:75], v20 offset:32768
    ds_read_b128 v[80:83], v28 offset:0
    v_lshlrev_b32 v4, 16, v42
    v_and_b32 v5, 0xffff0000, v42
    v_add_f32 v32, v32, v4
    v_mfma_f32_32x32x16_bf16 v[136:151], v[40:43], v[52:55], v[136:151]
    ds_read_b128 v[84:87], v28 offset:16384
    ds_read_b128 v[76:79], v20 offset:36864
    v_fmac_f32 v34, v4, v4
    v_add_f32 v36, v36, v5
    v_fmac_f32 v38, v5, v5
    v_mfma_f32_32x32x16_bf16 v[152:167], v[44:47], v[48:51], v[152:167]
    s_add_u32 s76, s76, 128
    s_and_b32 s76, s76, 0x3ff
    s_add_u32 m0, s8, 28672
    s_nop 0
    buffer_load_dwordx4 v8, s[40:43], s76 offen lds
    v_lshlrev_b32 v6, 16, v43
    v_and_b32 v7, 0xffff0000, v43
    v_add_f32 v32, v32, v6
    v_mfma_f32_32x32x16_bf16 v[168:183], v[44:47], v[52:55], v[168:183]
    s_add_u32 m0, s8, 29696
    s_nop 0
    buffer_load_dwordx4 v9, s[40:43], s76 offen lds
    v_fmac_f32 v34, v6, v6
    v_add_f32 v36, v36, v7
    v_fmac_f32 v38, v7, v7
    s_waitcnt lgkmcnt(4)
    v_mfma_f32_32x32x16_bf16 v[120:135], v[56:59], v[64:67], v[120:135]
    ds_read_b128 v[40:43], v21 offset:32768
    ds_read_b128 v[48:51], v29 offset:0
    v_lshlrev_b32 v4, 16, v62
    v_and_b32 v5, 0xffff0000, v62
    v_add_f32 v33, v33, v4
    v_mfma_f32_32x32x16_bf16 v[136:151], v[56:59], v[68:71], v[136:151]
    ds_read_b128 v[52:55], v29 offset:16384
    ds_read_b128 v[44:47], v21 offset:36864
    v_fmac_f32 v35, v4, v4
    v_add_f32 v37, v37, v5
    v_fmac_f32 v39, v5, v5
    v_mfma_f32_32x32x16_bf16 v[152:167], v[60:63], v[64:67], v[152:167]
    s_add_u32 m0, s8, 94208
    s_nop 0
    buffer_load_dwordx4 v12, s[44:47], s76 offen lds
    v_lshlrev_b32 v6, 16, v63
    v_and_b32 v7, 0xffff0000, v63
    v_add_f32 v33, v33, v6
    v_mfma_f32_32x32x16_bf16 v[168:183], v[60:63], v[68:71], v[168:183]
    v_fmac_f32 v35, v6, v6
    v_add_f32 v37, v37, v7
    v_fmac_f32 v39, v7, v7
    v_mov_b32 v2, 1
    buffer_store_dword v2, v18, s[72:75], 0 offen sc1
    s_waitcnt lgkmcnt(4)
    v_mfma_f32_32x32x16_bf16 v[120:135], v[72:75], v[80:83], v[120:135]
    ds_read_b128 v[56:59], v22 offset:32768
    ds_read_b128 v[64:67], v30 offset:0
    v_lshlrev_b32 v4, 16, v72
    v_and_b32 v5, 0xffff0000, v72
    v_add_f32 v32, v32, v4
    v_mfma_f32_32x32x16_bf16 v[136:151], v[72:75], v[84:87], v[136:151]
    ds_read_b128 v[68:71], v30 offset:16384
    ds_read_b128 v[60:63], v22 offset:36864
    v_fmac_f32 v34, v4, v4
    v_add_f32 v36, v36, v5
    v_fmac_f32 v38, v5, v5
    v_mfma_f32_32x32x16_bf16 v[152:167], v[76:79], v[80:83], v[152:167]
    s_add_u32 m0, s8, 95232
    s_nop 0
    buffer_load_dwordx4 v13, s[44:47], s76 offen lds
    v_lshlrev_b32 v6, 16, v73
    v_and_b32 v7, 0xffff0000, v73
    v_add_f32 v32, v32, v6
    v_mfma_f32_32x32x16_bf16 v[168:183], v[76:79], v[84:87], v[168:183]
    v_add_co_u32 v10, vcc, s76, v14
    s_add_u32 m0, s8, 110592
    s_nop 0
    v_addc_co_u32 v11, vcc, 0, v15, vcc
    global_load_lds_dwordx4 v[10:11], off
    v_fmac_f32 v34, v6, v6
    v_add_f32 v36, v36, v7
    v_fmac_f32 v38, v7, v7
    s_waitcnt lgkmcnt(4)
    v_mfma_f32_32x32x16_bf16 v[120:135], v[40:43], v[48:51], v[120:135]
    ds_read_b128 v[72:75], v23 offset:32768
    ds_read_b128 v[80:83], v31 offset:0
    v_lshlrev_b32 v4, 16, v44
    v_and_b32 v5, 0xffff0000, v44
    v_add_f32 v33, v33, v4
    v_mfma_f32_32x32x16_bf16 v[136:151], v[40:43], v[52:55], v[136:151]
    ds_read_b128 v[84:87], v31 offset:16384
    ds_read_b128 v[76:79], v23 offset:36864
    v_fmac_f32 v35, v4, v4
    v_add_f32 v37, v37, v5
    v_fmac_f32 v39, v5, v5
    v_mfma_f32_32x32x16_bf16 v[152:167], v[44:47], v[48:51], v[152:167]
    s_add_u32 m0, s8, 111616
    s_nop 0
    buffer_load_dwordx4 v13, s[48:51], s76 offen lds
    v_lshlrev_b32 v6, 16, v45
    v_and_b32 v7, 0xffff0000, v45
    v_add_f32 v33, v33, v6
    v_mfma_f32_32x32x16_bf16 v[168:183], v[44:47], v[52:55], v[168:183]
    v_fmac_f32 v35, v6, v6
    v_add_f32 v37, v37, v7
    v_fmac_f32 v39, v7, v7
    v_lshlrev_b32 v236, 4, v1
    v_and_b32 v2, 7, v1
    v_bfe_u32 v3, v1, 4, 1
    v_lshlrev_b32 v3, 2, v3
    v_xor_b32 v2, v2, v3
    v_lshlrev_b32 v2, 4, v2
    v_lshrrev_b32 v3, 3, v1
    v_lshl_add_u32 v2, v3, 10, v2
    s_lshl_b32 s14, s4, 13
    s_lshl_b32 s15, s28, 7
    s_add_u32 s15, s15, s14
    v_add_u32 v237, s15, v2
    s_waitcnt vmcnt(7) lgkmcnt(0)
    s_barrier
    v_mfma_f32_32x32x16_bf16 v[120:135], v[56:59], v[64:67], v[120:135]
    ds_read_b128 v[40:43], v20 offset:0
    ds_read_b128 v[48:51], v24 offset:0
    v_lshlrev_b32 v4, 16, v58
    v_and_b32 v5, 0xffff0000, v58
    v_add_f32 v32, v32, v4
    v_mfma_f32_32x32x16_bf16 v[136:151], v[56:59], v[68:71], v[136:151]
    ds_read_b128 v[52:55], v24 offset:16384
    ds_read_b128 v[44:47], v20 offset:4096
    v_fmac_f32 v34, v4, v4
    v_add_f32 v36, v36, v5
    v_fmac_f32 v38, v5, v5
    v_mfma_f32_32x32x16_bf16 v[152:167], v[60:63], v[64:67], v[152:167]
    s_add_u32 s76, s76, 128
    s_and_b32 s76, s76, 0x3ff
    s_add_u32 m0, s8, 45056
    s_nop 0
    buffer_load_dwordx4 v8, s[40:43], s76 offen lds
    v_lshlrev_b32 v6, 16, v59
    v_and_b32 v7, 0xffff0000, v59
    v_add_f32 v32, v32, v6
    v_mfma_f32_32x32x16_bf16 v[168:183], v[60:63], v[68:71], v[168:183]
    s_add_u32 m0, s8, 46080
    s_nop 0
    buffer_load_dwordx4 v9, s[40:43], s76 offen lds
    v_fmac_f32 v34, v6, v6
    v_add_f32 v36, v36, v7
    v_fmac_f32 v38, v7, v7
    s_waitcnt lgkmcnt(4)
    v_mfma_f32_32x32x16_bf16 v[120:135], v[72:75], v[80:83], v[120:135]
    ds_read_b128 v[56:59], v21 offset:0
    ds_read_b128 v[64:67], v25 offset:0
    v_lshlrev_b32 v4, 16, v78
    v_and_b32 v5, 0xffff0000, v78
    v_add_f32 v33, v33, v4
    v_mfma_f32_32x32x16_bf16 v[136:151], v[72:75], v[84:87], v[136:151]
    ds_read_b128 v[68:71], v25 offset:16384
    ds_read_b128 v[60:63], v21 offset:4096
    v_fmac_f32 v35, v4, v4
    v_add_f32 v37, v37, v5
    v_fmac_f32 v39, v5, v5
    v_mfma_f32_32x32x16_bf16 v[152:167], v[76:79], v[80:83], v[152:167]
    s_add_u32 m0, s8, 126976
    s_nop 0
    buffer_load_dwordx4 v12, s[44:47], s76 offen lds
    v_lshlrev_b32 v6, 16, v79
    v_and_b32 v7, 0xffff0000, v79
    v_add_f32 v33, v33, v6
    v_mfma_f32_32x32x16_bf16 v[168:183], v[76:79], v[84:87], v[168:183]
    v_fmac_f32 v35, v6, v6
    v_add_f32 v37, v37, v7
    v_fmac_f32 v39, v7, v7
    v_bfe_u32 v2, v1, 2, 2
    v_bfe_u32 v3, v1, 5, 1
    v_lshl_add_u32 v2, v3, 2, v2
    v_lshlrev_b32 v242, 7, v2
    v_bfe_u32 v2, v1, 3, 1
    v_bfe_u32 v3, v1, 4, 1
    v_lshl_or_b32 v2, v2, 1, v3
    v_xor_b32 v2, s5, v2
    v_lshl_add_u32 v242, v2, 5, v242
    v_and_b32 v2, 3, v1
    v_lshl_add_u32 v242, v2, 3, v242
    s_lshl_b32 s15, s5, 11
    v_add_u32 v242, s15, v242
    v_xor_b32 v243, 64, v242
    v_add_u32 v244, 65536, v242
    v_add_u32 v245, 65536, v243
    v_add_u32 v246, 131072, v242
    v_add_u32 v247, 131072, v243
    s_waitcnt lgkmcnt(4)
    v_mfma_f32_32x32x16_bf16 v[120:135], v[40:43], v[48:51], v[120:135]
    ds_read_b128 v[72:75], v22 offset:0
    ds_read_b128 v[80:83], v26 offset:0
    v_lshlrev_b32 v4, 16, v40
    v_and_b32 v5, 0xffff0000, v40
    v_add_f32 v32, v32, v4
    v_mfma_f32_32x32x16_bf16 v[136:151], v[40:43], v[52:55], v[136:151]
    ds_read_b128 v[84:87], v26 offset:16384
    ds_read_b128 v[76:79], v22 offset:4096
    v_fmac_f32 v34, v4, v4
    v_add_f32 v36, v36, v5
    v_fmac_f32 v38, v5, v5
    v_mfma_f32_32x32x16_bf16 v[152:167], v[44:47], v[48:51], v[152:167]
    s_add_u32 m0, s8, 128000
    s_nop 0
    buffer_load_dwordx4 v13, s[44:47], s76 offen lds
    v_lshlrev_b32 v6, 16, v41
    v_and_b32 v7, 0xffff0000, v41
    v_add_f32 v32, v32, v6
    v_mfma_f32_32x32x16_bf16 v[168:183], v[44:47], v[52:55], v[168:183]
    v_add_co_u32 v10, vcc, s76, v14
    s_add_u32 m0, s8, 143360
    s_nop 0
    v_addc_co_u32 v11, vcc, 0, v15, vcc
    global_load_lds_dwordx4 v[10:11], off
    v_fmac_f32 v34, v6, v6
    v_add_f32 v36, v36, v7
    v_fmac_f32 v38, v7, v7
    s_waitcnt lgkmcnt(4)
    v_mfma_f32_32x32x16_bf16 v[120:135], v[56:59], v[64:67], v[120:135]
    ds_read_b128 v[40:43], v23 offset:0
    ds_read_b128 v[48:51], v27 offset:0
    v_lshlrev_b32 v4, 16, v60
    v_and_b32 v5, 0xffff0000, v60
    v_add_f32 v33, v33, v4
    v_mfma_f32_32x32x16_bf16 v[136:151], v[56:59], v[68:71], v[136:151]
    ds_read_b128 v[52:55], v27 offset:16384
    ds_read_b128 v[44:47], v23 offset:4096
    v_fmac_f32 v35, v4, v4
    v_add_f32 v37, v37, v5
    v_fmac_f32 v39, v5, v5
    v_mfma_f32_32x32x16_bf16 v[152:167], v[60:63], v[64:67], v[152:167]
    s_add_u32 m0, s8, 144384
    s_nop 0
    buffer_load_dwordx4 v13, s[48:51], s76 offen lds
    v_lshlrev_b32 v6, 16, v61
    v_and_b32 v7, 0xffff0000, v61
    v_add_f32 v33, v33, v6
    v_mfma_f32_32x32x16_bf16 v[168:183], v[60:63], v[68:71], v[168:183]
    v_fmac_f32 v35, v6, v6
    v_add_f32 v37, v37, v7
    v_fmac_f32 v39, v7, v7
    v_lshrrev_b32 v2, 3, v1
    s_lshl_b32 s15, s5, 3
    v_add_u32 v2, s15, v2
    v_lshl_add_u32 v3, v2, 6, s23
    v_xor_b32 v3, s25, v3
    v_add_u32 v3, s24, v3
    v_and_b32 v3, 0x7ff, v3
    v_lshrrev_b32 v2, 1, v2
    v_xor_b32 v2, v2, v1
    v_and_b32 v2, 7, v2
    v_lshlrev_b32 v2, 4, v2
    v_lshl_add_u32 v238, v3, 12, v2
    s_waitcnt vmcnt(6) lgkmcnt(0)
    s_barrier
    v_mfma_f32_32x32x16_bf16 v[120:135], v[72:75], v[80:83], v[120:135]
    ds_read_b128 v[56:59], v20 offset:16384
    ds_read_b128 v[64:67], v24 offset:32768
    v_lshlrev_b32 v4, 16, v74
    v_and_b32 v5, 0xffff0000, v74
    v_add_f32 v32, v32, v4
    v_mfma_f32_32x32x16_bf16 v[136:151], v[72:75], v[84:87], v[136:151]
    ds_read_b128 v[68:71], v24 offset:49152
    ds_read_b128 v[60:63], v20 offset:20480
    v_fmac_f32 v34, v4, v4
    v_add_f32 v36, v36, v5
    v_fmac_f32 v38, v5, v5
    v_mfma_f32_32x32x16_bf16 v[152:167], v[76:79], v[80:83], v[152:167]
    s_add_u32 s76, s76, 128
    s_and_b32 s76, s76, 0x3ff
    s_add_u32 m0, s8, 12288
    s_nop 0
    buffer_load_dwordx4 v8, s[40:43], s76 offen lds
    v_lshlrev_b32 v6, 16, v75
    v_and_b32 v7, 0xffff0000, v75
    v_add_f32 v32, v32, v6
    v_mfma_f32_32x32x16_bf16 v[168:183], v[76:79], v[84:87], v[168:183]
    s_add_u32 m0, s8, 13312
    s_nop 0
    buffer_load_dwordx4 v9, s[40:43], s76 offen lds
    v_fmac_f32 v34, v6, v6
    v_add_f32 v36, v36, v7
    v_fmac_f32 v38, v7, v7
    s_waitcnt lgkmcnt(4)
    v_mfma_f32_32x32x16_bf16 v[120:135], v[40:43], v[48:51], v[120:135]
    ds_read_b128 v[72:75], v21 offset:16384
    ds_read_b128 v[80:83], v25 offset:32768
    v_lshlrev_b32 v4, 16, v46
    v_and_b32 v5, 0xffff0000, v46
    v_add_f32 v33, v33, v4
    v_mfma_f32_32x32x16_bf16 v[136:151], v[40:43], v[52:55], v[136:151]
    ds_read_b128 v[84:87], v25 offset:49152
    ds_read_b128 v[76:79], v21 offset:20480
    v_fmac_f32 v35, v4, v4
    v_add_f32 v37, v37, v5
    v_fmac_f32 v39, v5, v5
    v_mfma_f32_32x32x16_bf16 v[152:167], v[44:47], v[48:51], v[152:167]
    s_add_u32 m0, s8, 61440
    s_nop 0
    buffer_load_dwordx4 v12, s[44:47], s76 offen lds
    v_lshlrev_b32 v6, 16, v47
    v_and_b32 v7, 0xffff0000, v47
    v_add_f32 v33, v33, v6
    v_mfma_f32_32x32x16_bf16 v[168:183], v[44:47], v[52:55], v[168:183]
    v_fmac_f32 v35, v6, v6
    v_add_f32 v37, v37, v7
    v_fmac_f32 v39, v7, v7
    v_bfe_u32 v2, v1, 1, 3
    v_lshlrev_b32 v2, 4, v2
    v_and_b32 v3, 31, v1
    v_lshl_add_u32 v2, v3, 7, v2
    v_lshrrev_b32 v3, 5, v1
    v_lshl_add_u32 v2, v3, 3, v2
    s_lshl_b32 s15, s4, 12
    s_add_u32 s15, s15, 0
    v_add_u32 v248, s15, v2
    s_mul_i32 s15, s4, 151552
    s_add_u32 s15, s15, 8192
    v_add_u32 v239, s15, v2
    s_waitcnt lgkmcnt(4)
    v_mfma_f32_32x32x16_bf16 v[120:135], v[56:59], v[64:67], v[120:135]
    ds_read_b128 v[40:43], v22 offset:16384
    ds_read_b128 v[48:51], v26 offset:32768
    v_lshlrev_b32 v4, 16, v56
    v_and_b32 v5, 0xffff0000, v56
    v_add_f32 v32, v32, v4
    v_mfma_f32_32x32x16_bf16 v[136:151], v[56:59], v[68:71], v[136:151]
    ds_read_b128 v[52:55], v26 offset:49152
    ds_read_b128 v[44:47], v22 offset:20480
    v_fmac_f32 v34, v4, v4
    v_add_f32 v36, v36, v5
    v_fmac_f32 v38, v5, v5
    v_mfma_f32_32x32x16_bf16 v[152:167], v[60:63], v[64:67], v[152:167]
    s_add_u32 m0, s8, 62464
    s_nop 0
    buffer_load_dwordx4 v13, s[44:47], s76 offen lds
    v_lshlrev_b32 v6, 16, v57
    v_and_b32 v7, 0xffff0000, v57
    v_add_f32 v32, v32, v6
    v_mfma_f32_32x32x16_bf16 v[168:183], v[60:63], v[68:71], v[168:183]
    v_add_co_u32 v10, vcc, s76, v14
    s_add_u32 m0, s8, 77824
    s_nop 0
    v_addc_co_u32 v11, vcc, 0, v15, vcc
    global_load_lds_dwordx4 v[10:11], off
    v_fmac_f32 v34, v6, v6
    v_add_f32 v36, v36, v7
    v_fmac_f32 v38, v7, v7
    s_waitcnt lgkmcnt(4)
    v_mfma_f32_32x32x16_bf16 v[120:135], v[72:75], v[80:83], v[120:135]
    ds_read_b128 v[56:59], v23 offset:16384
    ds_read_b128 v[64:67], v27 offset:32768
    v_lshlrev_b32 v4, 16, v76
    v_and_b32 v5, 0xffff0000, v76
    v_add_f32 v33, v33, v4
    v_mfma_f32_32x32x16_bf16 v[136:151], v[72:75], v[84:87], v[136:151]
    ds_read_b128 v[68:71], v27 offset:49152
    ds_read_b128 v[60:63], v23 offset:20480
    v_fmac_f32 v35, v4, v4
    v_add_f32 v37, v37, v5
    v_fmac_f32 v39, v5, v5
    v_mfma_f32_32x32x16_bf16 v[152:167], v[76:79], v[80:83], v[152:167]
    s_add_u32 m0, s8, 78848
    s_nop 0
    buffer_load_dwordx4 v13, s[48:51], s76 offen lds
    v_lshlrev_b32 v6, 16, v77
    v_and_b32 v7, 0xffff0000, v77
    v_add_f32 v33, v33, v6
    v_mfma_f32_32x32x16_bf16 v[168:183], v[76:79], v[84:87], v[168:183]
    v_fmac_f32 v35, v6, v6
    v_add_f32 v37, v37, v7
    v_fmac_f32 v39, v7, v7
    v_and_b32 v2, 15, v1
    v_add_u32 v2, s26, v2
    v_xor_b32 v2, s25, v2
    v_add_u32 v2, s24, v2
    v_and_b32 v2, 0x1ff, v2
    v_lshrrev_b32 v3, 4, v1
    v_mul_u32_u24 v3, 288, v3
    v_add_u32 v2, v2, v3
    v_lshl_add_u32 v240, v2, 4, s27
    s_waitcnt vmcnt(6) lgkmcnt(0)
    s_barrier
    v_mfma_f32_32x32x16_bf16 v[120:135], v[40:43], v[48:51], v[120:135]
    ds_read_b128 v[72:75], v20 offset:32768
    ds_read_b128 v[80:83], v28 offset:0
    v_lshlrev_b32 v4, 16, v42
    v_and_b32 v5, 0xffff0000, v42
    v_add_f32 v32, v32, v4
    v_mfma_f32_32x32x16_bf16 v[136:151], v[40:43], v[52:55], v[136:151]
    ds_read_b128 v[84:87], v28 offset:16384
    ds_read_b128 v[76:79], v20 offset:36864
    v_fmac_f32 v34, v4, v4
    v_add_f32 v36, v36, v5
    v_fmac_f32 v38, v5, v5
    v_mfma_f32_32x32x16_bf16 v[152:167], v[44:47], v[48:51], v[152:167]
    s_add_u32 s76, s76, 128
    s_and_b32 s76, s76, 0x3ff
    s_add_u32 m0, s8, 28672
    s_nop 0
    buffer_load_dwordx4 v8, s[40:43], s76 offen lds
    v_lshlrev_b32 v6, 16, v43
    v_and_b32 v7, 0xffff0000, v43
    v_add_f32 v32, v32, v6
    v_mfma_f32_32x32x16_bf16 v[168:183], v[44:47], v[52:55], v[168:183]
    s_add_u32 m0, s8, 29696
    s_nop 0
    buffer_load_dwordx4 v9, s[40:43], s76 offen lds
    v_fmac_f32 v34, v6, v6
    v_add_f32 v36, v36, v7
    v_fmac_f32 v38, v7, v7
    s_waitcnt lgkmcnt(4)
    v_mfma_f32_32x32x16_bf16 v[120:135], v[56:59], v[64:67], v[120:135]
    ds_read_b128 v[40:43], v21 offset:32768
    ds_read_b128 v[48:51], v29 offset:0
    v_lshlrev_b32 v4, 16, v62
    v_and_b32 v5, 0xffff0000, v62
    v_add_f32 v33, v33, v4
    v_mfma_f32_32x32x16_bf16 v[136:151], v[56:59], v[68:71], v[136:151]
    ds_read_b128 v[52:55], v29 offset:16384
    ds_read_b128 v[44:47], v21 offset:36864
    v_fmac_f32 v35, v4, v4
    v_add_f32 v37, v37, v5
    v_fmac_f32 v39, v5, v5
    v_mfma_f32_32x32x16_bf16 v[152:167], v[60:63], v[64:67], v[152:167]
    s_add_u32 m0, s8, 94208
    s_nop 0
    buffer_load_dwordx4 v12, s[44:47], s76 offen lds
    v_lshlrev_b32 v6, 16, v63
    v_and_b32 v7, 0xffff0000, v63
    v_add_f32 v33, v33, v6
    v_mfma_f32_32x32x16_bf16 v[168:183], v[60:63], v[68:71], v[168:183]
    v_fmac_f32 v35, v6, v6
    v_add_f32 v37, v37, v7
    v_fmac_f32 v39, v7, v7
    v_and_b32 v2, 31, v1
    v_lshl_add_u32 v2, v2, 6, s23
    v_lshlrev_b32 v2, 10, v2
    v_lshrrev_b32 v3, 5, v1
    v_lshl_add_u32 v2, v3, 4, v2
    s_lshl_b32 s15, s26, 1
    v_add_u32 v241, s15, v2
    s_waitcnt lgkmcnt(4)
    v_mfma_f32_32x32x16_bf16 v[120:135], v[72:75], v[80:83], v[120:135]
    ds_read_b128 v[56:59], v22 offset:32768
    ds_read_b128 v[64:67], v30 offset:0
    v_lshlrev_b32 v4, 16, v72
    v_and_b32 v5, 0xffff0000, v72
    v_add_f32 v32, v32, v4
    v_mfma_f32_32x32x16_bf16 v[136:151], v[72:75], v[84:87], v[136:151]
    ds_read_b128 v[68:71], v30 offset:16384
    ds_read_b128 v[60:63], v22 offset:36864
    v_fmac_f32 v34, v4, v4
    v_add_f32 v36, v36, v5
    v_fmac_f32 v38, v5, v5
    v_mfma_f32_32x32x16_bf16 v[152:167], v[76:79], v[80:83], v[152:167]
    s_add_u32 m0, s8, 95232
    s_nop 0
    buffer_load_dwordx4 v13, s[44:47], s76 offen lds
    v_lshlrev_b32 v6, 16, v73
    v_and_b32 v7, 0xffff0000, v73
    v_add_f32 v32, v32, v6
    v_mfma_f32_32x32x16_bf16 v[168:183], v[76:79], v[84:87], v[168:183]
    v_add_co_u32 v10, vcc, s76, v14
    s_add_u32 m0, s8, 110592
    s_nop 0
    v_addc_co_u32 v11, vcc, 0, v15, vcc
    global_load_lds_dwordx4 v[10:11], off
    v_fmac_f32 v34, v6, v6
    v_add_f32 v36, v36, v7
    v_fmac_f32 v38, v7, v7
    s_waitcnt lgkmcnt(4)
    v_mfma_f32_32x32x16_bf16 v[120:135], v[40:43], v[48:51], v[120:135]
    ds_read_b128 v[72:75], v23 offset:32768
    ds_read_b128 v[80:83], v31 offset:0
    v_lshlrev_b32 v4, 16, v44
    v_and_b32 v5, 0xffff0000, v44
    v_add_f32 v33, v33, v4
    v_mfma_f32_32x32x16_bf16 v[136:151], v[40:43], v[52:55], v[136:151]
    ds_read_b128 v[84:87], v31 offset:16384
    ds_read_b128 v[76:79], v23 offset:36864
    v_fmac_f32 v35, v4, v4
    v_add_f32 v37, v37, v5
    v_fmac_f32 v39, v5, v5
    v_mfma_f32_32x32x16_bf16 v[152:167], v[44:47], v[48:51], v[152:167]
    s_add_u32 m0, s8, 111616
    s_nop 0
    buffer_load_dwordx4 v13, s[48:51], s76 offen lds
    v_lshlrev_b32 v6, 16, v45
    v_and_b32 v7, 0xffff0000, v45
    v_add_f32 v33, v33, v6
    v_mfma_f32_32x32x16_bf16 v[168:183], v[44:47], v[52:55], v[168:183]
    v_fmac_f32 v35, v6, v6
    v_add_f32 v37, v37, v7
    v_fmac_f32 v39, v7, v7
    s_waitcnt vmcnt(6) lgkmcnt(0)
    s_barrier
    v_mfma_f32_32x32x16_bf16 v[120:135], v[56:59], v[64:67], v[120:135]
    ds_read_b128 v[40:43], v20 offset:0
    ds_read_b128 v[48:51], v24 offset:0
    v_lshlrev_b32 v4, 16, v58
    v_and_b32 v5, 0xffff0000, v58
    v_add_f32 v32, v32, v4
    v_mfma_f32_32x32x16_bf16 v[136:151], v[56:59], v[68:71], v[136:151]
    ds_read_b128 v[52:55], v24 offset:16384
    ds_read_b128 v[44:47], v20 offset:4096
    v_fmac_f32 v34, v4, v4
    v_add_f32 v36, v36, v5
    v_fmac_f32 v38, v5, v5
    v_mfma_f32_32x32x16_bf16 v[152:167], v[60:63], v[64:67], v[152:167]
    s_add_u32 m0, s80, 45056
    s_add_u32 s12, s16, 0
    buffer_load_dwordx4 v237, s[64:67], s12 offen lds
    v_lshlrev_b32 v6, 16, v59
    v_and_b32 v7, 0xffff0000, v59
    v_add_f32 v32, v32, v6
    v_mfma_f32_32x32x16_bf16 v[168:183], v[60:63], v[68:71], v[168:183]
    s_add_u32 m0, s80, 53248
    s_add_u32 s12, s16, 16384
    buffer_load_dwordx4 v237, s[64:67], s12 offen lds
    v_fmac_f32 v34, v6, v6
    v_add_f32 v36, v36, v7
    v_fmac_f32 v38, v7, v7
    s_waitcnt lgkmcnt(4)
    v_mfma_f32_32x32x16_bf16 v[120:135], v[72:75], v[80:83], v[120:135]
    ds_read_b128 v[56:59], v21 offset:0
    ds_read_b128 v[64:67], v25 offset:0
    v_lshlrev_b32 v4, 16, v78
    v_and_b32 v5, 0xffff0000, v78
    v_add_f32 v33, v33, v4
    v_mfma_f32_32x32x16_bf16 v[136:151], v[72:75], v[84:87], v[136:151]
    ds_read_b128 v[68:71], v25 offset:16384
    ds_read_b128 v[60:63], v21 offset:4096
    v_fmac_f32 v35, v4, v4
    v_add_f32 v37, v37, v5
    v_fmac_f32 v39, v5, v5
    v_mfma_f32_32x32x16_bf16 v[152:167], v[76:79], v[80:83], v[152:167]
    s_add_u32 m0, s80, 126976
    s_add_u32 s12, s17, 0
    buffer_load_dwordx4 v237, s[64:67], s12 offen lds
    v_lshlrev_b32 v6, 16, v79
    v_and_b32 v7, 0xffff0000, v79
    v_add_f32 v33, v33, v6
    v_mfma_f32_32x32x16_bf16 v[168:183], v[76:79], v[84:87], v[168:183]
    v_fmac_f32 v35, v6, v6
    v_add_f32 v37, v37, v7
    v_fmac_f32 v39, v7, v7
    s_lshl_b32 s15, s3, 10
    v_add_u32 v249, s15, v236
    v_add_u32 v251, 0, v249
    v_xor_b32 v255, 3072, v251
    v_add_u32 v250, 65536, v249
    v_xor_b32 v253, 2048, v250
    v_add_u32 v249, 65536, v249
    v_xor_b32 v252, 1024, v249
    s_waitcnt lgkmcnt(4)
    v_mfma_f32_32x32x16_bf16 v[120:135], v[40:43], v[48:51], v[120:135]
    ds_read_b128 v[72:75], v22 offset:0
    ds_read_b128 v[80:83], v26 offset:0
    v_lshlrev_b32 v4, 16, v40
    v_and_b32 v5, 0xffff0000, v40
    v_add_f32 v32, v32, v4
    v_mfma_f32_32x32x16_bf16 v[136:151], v[40:43], v[52:55], v[136:151]
    ds_read_b128 v[84:87], v26 offset:16384
    ds_read_b128 v[76:79], v22 offset:4096
    v_fmac_f32 v34, v4, v4
    v_add_f32 v36, v36, v5
    v_fmac_f32 v38, v5, v5
    v_mfma_f32_32x32x16_bf16 v[152:167], v[44:47], v[48:51], v[152:167]
    s_add_u32 m0, s80, 135168
    s_add_u32 s12, s17, 16384
    buffer_load_dwordx4 v237, s[64:67], s12 offen lds
    v_lshlrev_b32 v6, 16, v41
    v_and_b32 v7, 0xffff0000, v41
    v_add_f32 v32, v32, v6
    v_mfma_f32_32x32x16_bf16 v[168:183], v[44:47], v[52:55], v[168:183]
    s_add_u32 m0, s80, 143360
    s_add_u32 s12, s18, 0
    buffer_load_dwordx4 v237, s[64:67], s12 offen lds
    v_fmac_f32 v34, v6, v6
    v_add_f32 v36, v36, v7
    v_fmac_f32 v38, v7, v7
    s_waitcnt lgkmcnt(4)
    v_mfma_f32_32x32x16_bf16 v[120:135], v[56:59], v[64:67], v[120:135]
    ds_read_b128 v[40:43], v23 offset:0
    ds_read_b128 v[48:51], v27 offset:0
    v_lshlrev_b32 v4, 16, v60
    v_and_b32 v5, 0xffff0000, v60
    v_add_f32 v33, v33, v4
    v_mfma_f32_32x32x16_bf16 v[136:151], v[56:59], v[68:71], v[136:151]
    ds_read_b128 v[52:55], v27 offset:16384
    ds_read_b128 v[44:47], v23 offset:4096
    v_fmac_f32 v35, v4, v4
    v_add_f32 v37, v37, v5
    v_fmac_f32 v39, v5, v5
    v_mfma_f32_32x32x16_bf16 v[152:167], v[60:63], v[64:67], v[152:167]
    s_add_u32 m0, s80, 151552
    s_add_u32 s12, s18, 16384
    buffer_load_dwordx4 v237, s[64:67], s12 offen lds
    v_lshlrev_b32 v6, 16, v61
    v_and_b32 v7, 0xffff0000, v61
    v_add_f32 v33, v33, v6
    v_mfma_f32_32x32x16_bf16 v[168:183], v[60:63], v[68:71], v[168:183]
    buffer_load_dword v19, off, s[72:75], 0 sc1
    v_fmac_f32 v35, v6, v6
    v_add_f32 v37, v37, v7
    v_fmac_f32 v39, v7, v7
    s_lshr_b32 s15, s23, 2
    s_lshl_b32 s15, s15, 4
    v_and_b32 v2, 15, v1
    v_lshlrev_b32 v3, 2, v2
    v_add_u32 v2, s15, v2
    v_lshlrev_b32 v2, 7, v2
    v_bfe_u32 v254, v1, 4, 1
    v_lshl_add_u32 v3, v254, 7, v3
    v_add_u32 v3, 1792, v3
    v_cmp_gt_u32 vcc, 32, v1
    s_mov_b32 s15, 12582912
    s_nop 0
    v_cndmask_b32 v2, v3, v2, vcc
    v_add_u32 v254, s15, v2
    s_waitcnt vmcnt(7) lgkmcnt(0)
    s_barrier
    v_mfma_f32_32x32x16_bf16 v[120:135], v[72:75], v[80:83], v[120:135]
    ds_read_b128 v[56:59], v20 offset:16384
    ds_read_b128 v[64:67], v24 offset:32768
    v_lshlrev_b32 v4, 16, v74
    v_and_b32 v5, 0xffff0000, v74
    v_add_f32 v32, v32, v4
    v_mfma_f32_32x32x16_bf16 v[136:151], v[72:75], v[84:87], v[136:151]
    ds_read_b128 v[68:71], v24 offset:49152
    ds_read_b128 v[60:63], v20 offset:20480
    v_fmac_f32 v34, v4, v4
    v_add_f32 v36, v36, v5
    v_fmac_f32 v38, v5, v5
    v_mfma_f32_32x32x16_bf16 v[152:167], v[76:79], v[80:83], v[152:167]
    s_add_u32 m0, s80, 12288
    s_add_u32 s12, s19, 0
    buffer_load_dwordx4 v237, s[64:67], s12 offen lds
    v_lshlrev_b32 v6, 16, v75
    v_and_b32 v7, 0xffff0000, v75
    v_add_f32 v32, v32, v6
    v_mfma_f32_32x32x16_bf16 v[168:183], v[76:79], v[84:87], v[168:183]
    s_add_u32 m0, s80, 20480
    s_add_u32 s12, s19, 16384
    buffer_load_dwordx4 v237, s[64:67], s12 offen lds
    v_fmac_f32 v34, v6, v6
    v_add_f32 v36, v36, v7
    v_fmac_f32 v38, v7, v7
    s_waitcnt lgkmcnt(4)
    v_mfma_f32_32x32x16_bf16 v[120:135], v[40:43], v[48:51], v[120:135]
    ds_read_b128 v[72:75], v21 offset:16384
    ds_read_b128 v[80:83], v25 offset:32768
    v_lshlrev_b32 v4, 16, v46
    v_and_b32 v5, 0xffff0000, v46
    v_add_f32 v33, v33, v4
    v_mfma_f32_32x32x16_bf16 v[136:151], v[40:43], v[52:55], v[136:151]
    ds_read_b128 v[84:87], v25 offset:49152
    ds_read_b128 v[76:79], v21 offset:20480
    v_fmac_f32 v35, v4, v4
    v_add_f32 v37, v37, v5
    v_fmac_f32 v39, v5, v5
    v_mfma_f32_32x32x16_bf16 v[152:167], v[44:47], v[48:51], v[152:167]
    s_add_u32 m0, s80, 61440
    s_add_u32 s12, s20, 0
    buffer_load_dwordx4 v237, s[64:67], s12 offen lds
    v_lshlrev_b32 v6, 16, v47
    v_and_b32 v7, 0xffff0000, v47
    v_add_f32 v33, v33, v6
    v_mfma_f32_32x32x16_bf16 v[168:183], v[44:47], v[52:55], v[168:183]
    v_fmac_f32 v35, v6, v6
    v_add_f32 v37, v37, v7
    v_fmac_f32 v39, v7, v7
    s_waitcnt lgkmcnt(4)
    v_mfma_f32_32x32x16_bf16 v[120:135], v[56:59], v[64:67], v[120:135]
    ds_read_b128 v[40:43], v22 offset:16384
    ds_read_b128 v[48:51], v26 offset:32768
    v_lshlrev_b32 v4, 16, v56
    v_and_b32 v5, 0xffff0000, v56
    v_add_f32 v32, v32, v4
    v_fmac_f32 v34, v4, v4
    v_add_f32 v36, v36, v5
    v_fmac_f32 v38, v5, v5
    v_mfma_f32_32x32x16_bf16 v[136:151], v[56:59], v[68:71], v[136:151]
    ds_read_b128 v[52:55], v26 offset:49152
    ds_read_b128 v[44:47], v22 offset:20480
    v_lshlrev_b32 v6, 16, v57
    v_and_b32 v7, 0xffff0000, v57
    v_add_f32 v32, v32, v6
    v_fmac_f32 v34, v6, v6
    v_add_f32 v36, v36, v7
    v_fmac_f32 v38, v7, v7
    v_mfma_f32_32x32x16_bf16 v[152:167], v[60:63], v[64:67], v[152:167]
    s_add_u32 m0, s80, 69632
    s_add_u32 s12, s20, 16384
    buffer_load_dwordx4 v237, s[64:67], s12 offen lds
    v_lshlrev_b32 v4, 16, v58
    v_and_b32 v5, 0xffff0000, v58
    v_add_f32 v32, v32, v4
    v_fmac_f32 v34, v4, v4
    v_add_f32 v36, v36, v5
    v_fmac_f32 v38, v5, v5
    v_mfma_f32_32x32x16_bf16 v[168:183], v[60:63], v[68:71], v[168:183]
    s_add_u32 m0, s80, 77824
    s_add_u32 s12, s21, 0
    buffer_load_dwordx4 v237, s[64:67], s12 offen lds
    v_lshlrev_b32 v6, 16, v59
    v_and_b32 v7, 0xffff0000, v59
    v_add_f32 v32, v32, v6
    v_fmac_f32 v34, v6, v6
    v_add_f32 v36, v36, v7
    v_fmac_f32 v38, v7, v7
    s_waitcnt lgkmcnt(4)
    v_mfma_f32_32x32x16_bf16 v[120:135], v[72:75], v[80:83], v[120:135]
    ds_read_b128 v[56:59], v23 offset:16384
    ds_read_b128 v[64:67], v27 offset:32768
    v_lshlrev_b32 v4, 16, v76
    v_and_b32 v5, 0xffff0000, v76
    v_add_f32 v33, v33, v4
    v_fmac_f32 v35, v4, v4
    v_add_f32 v37, v37, v5
    v_fmac_f32 v39, v5, v5
    v_mfma_f32_32x32x16_bf16 v[136:151], v[72:75], v[84:87], v[136:151]
    ds_read_b128 v[68:71], v27 offset:49152
    ds_read_b128 v[60:63], v23 offset:20480
    v_lshlrev_b32 v6, 16, v77
    v_and_b32 v7, 0xffff0000, v77
    v_add_f32 v33, v33, v6
    v_fmac_f32 v35, v6, v6
    v_add_f32 v37, v37, v7
    v_fmac_f32 v39, v7, v7
    v_mfma_f32_32x32x16_bf16 v[152:167], v[76:79], v[80:83], v[152:167]
    s_add_u32 m0, s80, 86016
    s_add_u32 s12, s21, 16384
    buffer_load_dwordx4 v237, s[64:67], s12 offen lds
    v_lshlrev_b32 v4, 16, v78
    v_and_b32 v5, 0xffff0000, v78
    v_add_f32 v33, v33, v4
    v_fmac_f32 v35, v4, v4
    v_add_f32 v37, v37, v5
    v_fmac_f32 v39, v5, v5
    v_mfma_f32_32x32x16_bf16 v[168:183], v[76:79], v[84:87], v[168:183]
    v_lshlrev_b32 v6, 16, v79
    v_and_b32 v7, 0xffff0000, v79
    v_add_f32 v33, v33, v6
    v_fmac_f32 v35, v6, v6
    v_add_f32 v37, v37, v7
    v_fmac_f32 v39, v7, v7
    v_add_f32 v32, v32, v36
    v_add_f32 v33, v33, v37
    v_add_f32 v34, v34, v38
    v_add_f32 v35, v35, v39
    v_lshlrev_b32 v2, 4, v0
    ds_write_b128 v2, v[32:35] offset:0
    v_and_b32 v2, 31, v1
    v_lshlrev_b32 v2, 4, v2
    s_lshl_b32 s10, s4, 12
    v_add_u32 v2, s10, v2
    s_waitcnt lgkmcnt(0)
    s_barrier
    ds_read_b128 v[184:187], v2 offset:0
    ds_read_b128 v[188:191], v2 offset:512
    ds_read_b128 v[192:195], v2 offset:1024
    ds_read_b128 v[196:199], v2 offset:1536
    ds_read_b128 v[200:203], v2 offset:2048
    ds_read_b128 v[204:207], v2 offset:2560
    ds_read_b128 v[208:211], v2 offset:3072
    ds_read_b128 v[212:215], v2 offset:3584
    v_mfma_f32_32x32x16_bf16 v[120:135], v[40:43], v[48:51], v[120:135]
    v_mfma_f32_32x32x16_bf16 v[136:151], v[40:43], v[52:55], v[136:151]
    s_add_u32 m0, s80, 28672
    s_add_u32 s12, s22, 0
    buffer_load_dwordx4 v237, s[64:67], s12 offen lds
    v_mfma_f32_32x32x16_bf16 v[152:167], v[44:47], v[48:51], v[152:167]
    s_add_u32 m0, s80, 36864
    s_add_u32 s12, s22, 16384
    buffer_load_dwordx4 v237, s[64:67], s12 offen lds
    v_mfma_f32_32x32x16_bf16 v[168:183], v[44:47], v[52:55], v[168:183]
    s_add_u32 m0, s80, 94208
    s_add_u32 s12, s16, 65536
    buffer_load_dwordx4 v237, s[64:67], s12 offen lds
    v_mfma_f32_32x32x16_bf16 v[120:135], v[56:59], v[64:67], v[120:135]
    v_mfma_f32_32x32x16_bf16 v[136:151], v[56:59], v[68:71], v[136:151]
    s_add_u32 m0, s80, 102400
    s_add_u32 s12, s16, 81920
    buffer_load_dwordx4 v237, s[64:67], s12 offen lds
    v_mfma_f32_32x32x16_bf16 v[152:167], v[60:63], v[64:67], v[152:167]
    s_add_u32 m0, s80, 110592
    s_add_u32 s12, s17, 65536
    buffer_load_dwordx4 v237, s[64:67], s12 offen lds
    v_mfma_f32_32x32x16_bf16 v[168:183], v[60:63], v[68:71], v[168:183]
    s_add_u32 m0, s80, 118784
    s_add_u32 s12, s17, 81920
    buffer_load_dwordx4 v237, s[64:67], s12 offen lds
    s_waitcnt lgkmcnt(0)
    v_pk_add_f32 v[184:185], v[184:185], v[200:201]
    v_pk_add_f32 v[186:187], v[186:187], v[202:203]
    v_pk_add_f32 v[188:189], v[188:189], v[204:205]
    v_pk_add_f32 v[190:191], v[190:191], v[206:207]
    v_pk_add_f32 v[192:193], v[192:193], v[208:209]
    v_pk_add_f32 v[194:195], v[194:195], v[210:211]
    v_pk_add_f32 v[196:197], v[196:197], v[212:213]
    v_pk_add_f32 v[198:199], v[198:199], v[214:215]
    v_pk_add_f32 v[184:185], v[184:185], v[192:193]
    v_pk_add_f32 v[186:187], v[186:187], v[194:195]
    v_pk_add_f32 v[188:189], v[188:189], v[196:197]
    v_pk_add_f32 v[190:191], v[190:191], v[198:199]
    v_pk_add_f32 v[184:185], v[184:185], v[188:189]
    v_pk_add_f32 v[186:187], v[186:187], v[190:191]
    s_mov_b32 s10, 0x3b000000
    v_mul_f32 v188, s10, v184
    v_mul_f32 v190, s10, v186
    v_mul_f32 v189, s10, v185
    v_mul_f32 v191, s10, v187
    v_fma_f32 v190, -v188, v188, v190
    v_cvt_pk_bf16_f32 v88, -v188, -v188
    v_fma_f32 v191, -v189, v189, v191
    v_cvt_pk_bf16_f32 v92, -v189, -v189
    v_max_f32 v190, 0, v190
    v_max_f32 v191, 0, v191
    s_sub_u32 s14, s7, 14
    s_lshl_b32 s14, s14, 7
    s_lshl_b32 s12, s5, 5
    s_add_u32 s14, s14, s12
    v_add_u32 v2, s14, v1
    v_cmp_eq_u32 vcc, 0, v2
    v_mov_b32 v2, 0x4400
    s_nop 0
    v_cndmask_b32 v96, 0, v2, vcc
    s_nop 1
    v_mfma_f32_32x32x16_bf16 v[120:135], v[88:91], v[96:99], v[120:135]
    v_mfma_f32_32x32x16_bf16 v[152:167], v[92:95], v[96:99], v[152:167]
    v_cvt_pk_bf16_f32 v191, v190, v191
    v_lshlrev_b32 v190, 16, v191
    v_and_b32 v191, 0xffff0000, v191
    v_add_f32 v190, 0x3727c5ac, v190
    v_add_f32 v191, 0x3727c5ac, v191
    v_cvt_pk_bf16_f32 v191, v190, v191
    v_lshlrev_b32 v190, 16, v191
    v_and_b32 v191, 0xffff0000, v191
    v_sqrt_f32 v196, v190
    v_sqrt_f32 v197, v191
    s_nop 0
    v_cvt_pk_bf16_f32 v197, v196, v197
    v_lshlrev_b32 v196, 16, v197
    v_and_b32 v197, 0xffff0000, v197
    v_rcp_f32 v198, v196
    v_rcp_f32 v199, v197
    v_and_b32 v2, 31, v1
    s_lshl_b32 s10, s3, 8
    s_add_u32 s10, s10, 159744
    v_lshl_add_u32 v4, v2, 2, s10
    v_lshrrev_b32 v3, 5, v1
    v_lshl_add_u32 v5, v3, 4, s10
    ds_write_b32 v4, v198 offset:0
    ds_write_b32 v4, v199 offset:128
    s_waitcnt lgkmcnt(0)
    ds_read_b128 v[200:203], v5 offset:0
    ds_read_b128 v[204:207], v5 offset:32
    ds_read_b128 v[208:211], v5 offset:64
    ds_read_b128 v[212:215], v5 offset:96
    ds_read_b128 v[216:219], v5 offset:128
    ds_read_b128 v[220:223], v5 offset:160
    ds_read_b128 v[224:227], v5 offset:192
    ds_read_b128 v[228:231], v5 offset:224
    s_mov_b32 s13, 0x80008000
    v_mul_u32_u24 v3, 18432, v3
    s_lshl_b32 s10, s6, 1
    s_add_u32 s10, s10, s4
    s_mul_i32 s10, s10, 288
    s_add_u32 s10, s10, s14
    v_add3_u32 v4, v3, v2, s10
    s_mov_b32 s12, 8388608
    v_lshl_add_u32 v4, v4, 4, s12
    v_xor_b32 v88, s13, v104
    v_xor_b32 v89, s13, v105
    v_xor_b32 v90, s13, v106
    v_xor_b32 v91, s13, v107
    v_xor_b32 v92, s13, v108
    v_xor_b32 v93, s13, v109
    v_xor_b32 v94, s13, v110
    v_xor_b32 v95, s13, v111
    s_waitcnt vmcnt(12)
L_armD:
    v_readfirstlane_b32 s12, v19
    s_add_u32 s84, s84, 1
    s_cmp_lg_u32 s12, 0
    s_cbranch_scc1 L_armdD
    buffer_load_dword v19, off, s[72:75], 0 sc1
    s_waitcnt vmcnt(0)
    s_cmp_lt_u32 s84, 200000
    s_cbranch_scc1 L_armD
L_armdD:
    v_cmp_eq_u32 vcc, 0, v2
    s_cmp_lg_u32 s14, 0
    s_cselect_b64 s[10:11], 0, vcc
    s_waitcnt lgkmcnt(4)
    v_mul_f32 v120, v120, v200
    v_mul_f32 v121, v121, v201
    v_mul_f32 v122, v122, v202
    v_mul_f32 v123, v123, v203
    v_mul_f32 v124, v124, v204
    v_mul_f32 v125, v125, v205
    v_mul_f32 v126, v126, v206
    v_mul_f32 v127, v127, v207
    v_mul_f32 v128, v128, v208
    v_mul_f32 v129, v129, v209
    v_mul_f32 v130, v130, v210
    v_mul_f32 v131, v131, v211
    v_mul_f32 v132, v132, v212
    v_mul_f32 v133, v133, v213
    v_mul_f32 v134, v134, v214
    v_mul_f32 v135, v135, v215
    v_cvt_pk_bf16_f32 v40, v120, v121
    v_cvt_pk_bf16_f32 v41, v122, v123
    v_cvt_pk_bf16_f32 v42, v124, v125
    v_cvt_pk_bf16_f32 v43, v126, v127
    v_cvt_pk_bf16_f32 v44, v128, v129
    v_cvt_pk_bf16_f32 v45, v130, v131
    v_cvt_pk_bf16_f32 v46, v132, v133
    v_cvt_pk_bf16_f32 v47, v134, v135
    v_mul_f32 v136, v136, v200
    v_mul_f32 v137, v137, v201
    v_mul_f32 v138, v138, v202
    v_mul_f32 v139, v139, v203
    v_mul_f32 v140, v140, v204
    v_mul_f32 v141, v141, v205
    v_mul_f32 v142, v142, v206
    v_mul_f32 v143, v143, v207
    v_mul_f32 v144, v144, v208
    v_mul_f32 v145, v145, v209
    v_mul_f32 v146, v146, v210
    v_mul_f32 v147, v147, v211
    v_mul_f32 v148, v148, v212
    v_mul_f32 v149, v149, v213
    v_mul_f32 v150, v150, v214
    v_mul_f32 v151, v151, v215
    v_cvt_pk_bf16_f32 v72, v136, v137
    v_cvt_pk_bf16_f32 v73, v138, v139
    v_cvt_pk_bf16_f32 v74, v140, v141
    v_cvt_pk_bf16_f32 v75, v142, v143
    v_cvt_pk_bf16_f32 v76, v144, v145
    v_cvt_pk_bf16_f32 v77, v146, v147
    v_cvt_pk_bf16_f32 v78, v148, v149
    v_cvt_pk_bf16_f32 v79, v150, v151
    v_cndmask_b32 v48, v72, 0, s[10:11]
    v_cndmask_b32 v49, v73, 0, s[10:11]
    v_cndmask_b32 v50, v74, 0, s[10:11]
    v_cndmask_b32 v51, v75, 0, s[10:11]
    v_cndmask_b32 v52, v76, 0, s[10:11]
    v_cndmask_b32 v53, v77, 0, s[10:11]
    v_cndmask_b32 v54, v78, 0, s[10:11]
    v_cndmask_b32 v55, v79, 0, s[10:11]
    v_mfma_f32_32x32x16_bf16 v[120:135], v[104:107], v[40:43], 0
    v_mfma_f32_32x32x16_bf16 v[120:135], v[108:111], v[44:47], v[120:135]
    v_mfma_f32_32x32x16_bf16 v[120:135], v[112:115], v[48:51], v[120:135]
    v_mfma_f32_32x32x16_bf16 v[120:135], v[116:119], v[52:55], v[120:135]
    v_mfma_f32_32x32x16_bf16 v[136:151], v[112:115], v[40:43], 0
    v_mfma_f32_32x32x16_bf16 v[136:151], v[116:119], v[44:47], v[136:151]
    v_mfma_f32_32x32x16_bf16 v[136:151], v[88:91], v[48:51], v[136:151]
    v_mfma_f32_32x32x16_bf16 v[136:151], v[92:95], v[52:55], v[136:151]
    s_waitcnt lgkmcnt(0)
    v_mul_f32 v152, v152, v216
    v_mul_f32 v153, v153, v217
    v_mul_f32 v154, v154, v218
    v_mul_f32 v155, v155, v219
    v_mul_f32 v156, v156, v220
    v_mul_f32 v157, v157, v221
    v_mul_f32 v158, v158, v222
    v_mul_f32 v159, v159, v223
    v_mul_f32 v160, v160, v224
    v_mul_f32 v161, v161, v225
    v_mul_f32 v162, v162, v226
    v_mul_f32 v163, v163, v227
    v_mul_f32 v164, v164, v228
    v_mul_f32 v165, v165, v229
    v_mul_f32 v166, v166, v230
    v_mul_f32 v167, v167, v231
    v_cvt_pk_bf16_f32 v56, v152, v153
    v_cvt_pk_bf16_f32 v57, v154, v155
    v_cvt_pk_bf16_f32 v58, v156, v157
    v_cvt_pk_bf16_f32 v59, v158, v159
    v_cvt_pk_bf16_f32 v60, v160, v161
    v_cvt_pk_bf16_f32 v61, v162, v163
    v_cvt_pk_bf16_f32 v62, v164, v165
    v_cvt_pk_bf16_f32 v63, v166, v167
    v_mul_f32 v168, v168, v216
    v_mul_f32 v169, v169, v217
    v_mul_f32 v170, v170, v218
    v_mul_f32 v171, v171, v219
    v_mul_f32 v172, v172, v220
    v_mul_f32 v173, v173, v221
    v_mul_f32 v174, v174, v222
    v_mul_f32 v175, v175, v223
    v_mul_f32 v176, v176, v224
    v_mul_f32 v177, v177, v225
    v_mul_f32 v178, v178, v226
    v_mul_f32 v179, v179, v227
    v_mul_f32 v180, v180, v228
    v_mul_f32 v181, v181, v229
    v_mul_f32 v182, v182, v230
    v_mul_f32 v183, v183, v231
    v_cvt_pk_bf16_f32 v80, v168, v169
    v_cvt_pk_bf16_f32 v81, v170, v171
    v_cvt_pk_bf16_f32 v82, v172, v173
    v_cvt_pk_bf16_f32 v83, v174, v175
    v_cvt_pk_bf16_f32 v84, v176, v177
    v_cvt_pk_bf16_f32 v85, v178, v179
    v_cvt_pk_bf16_f32 v86, v180, v181
    v_cvt_pk_bf16_f32 v87, v182, v183
    v_cndmask_b32 v64, v80, 0, s[10:11]
    v_cndmask_b32 v65, v81, 0, s[10:11]
    v_cndmask_b32 v66, v82, 0, s[10:11]
    v_cndmask_b32 v67, v83, 0, s[10:11]
    v_cndmask_b32 v68, v84, 0, s[10:11]
    v_cndmask_b32 v69, v85, 0, s[10:11]
    v_cndmask_b32 v70, v86, 0, s[10:11]
    v_cndmask_b32 v71, v87, 0, s[10:11]
    v_mfma_f32_32x32x16_bf16 v[152:167], v[104:107], v[56:59], 0
    v_mfma_f32_32x32x16_bf16 v[152:167], v[108:111], v[60:63], v[152:167]
    v_mfma_f32_32x32x16_bf16 v[152:167], v[112:115], v[64:67], v[152:167]
    v_mfma_f32_32x32x16_bf16 v[152:167], v[116:119], v[68:71], v[152:167]
    v_mfma_f32_32x32x16_bf16 v[168:183], v[112:115], v[56:59], 0
    v_mfma_f32_32x32x16_bf16 v[168:183], v[116:119], v[60:63], v[168:183]
    v_mfma_f32_32x32x16_bf16 v[168:183], v[88:91], v[64:67], v[168:183]
    v_mfma_f32_32x32x16_bf16 v[168:183], v[92:95], v[68:71], v[168:183]
    s_waitcnt vmcnt(8)
    s_nop 6
    v_cvt_pk_bf16_f32 v200, v120, v152
    s_nop 2
    v_cvt_pk_bf16_f32 v201, v136, v168
    v_cvt_pk_bf16_f32 v202, v121, v153
    v_cvt_pk_bf16_f32 v203, v137, v169
    s_mov_b32 s13, 0
    buffer_store_dwordx4 v[200:203], v4, s[52:55], s13 offen sc1
    v_cvt_pk_bf16_f32 v204, v122, v154
    v_cvt_pk_bf16_f32 v205, v138, v170
    v_cvt_pk_bf16_f32 v206, v123, v155
    v_cvt_pk_bf16_f32 v207, v139, v171
    s_mov_b32 s13, 147456
    buffer_store_dwordx4 v[204:207], v4, s[52:55], s13 offen sc1
    v_cvt_pk_bf16_f32 v208, v124, v156
    v_cvt_pk_bf16_f32 v209, v140, v172
    v_cvt_pk_bf16_f32 v210, v125, v157
    v_cvt_pk_bf16_f32 v211, v141, v173
    s_mov_b32 s13, 589824
    buffer_store_dwordx4 v[208:211], v4, s[52:55], s13 offen sc1
    v_cvt_pk_bf16_f32 v212, v126, v158
    v_cvt_pk_bf16_f32 v213, v142, v174
    v_cvt_pk_bf16_f32 v214, v127, v159
    v_cvt_pk_bf16_f32 v215, v143, v175
    s_mov_b32 s13, 737280
    buffer_store_dwordx4 v[212:215], v4, s[52:55], s13 offen sc1
    v_cvt_pk_bf16_f32 v216, v128, v160
    v_cvt_pk_bf16_f32 v217, v144, v176
    v_cvt_pk_bf16_f32 v218, v129, v161
    v_cvt_pk_bf16_f32 v219, v145, v177
    s_mov_b32 s13, 1179648
    buffer_store_dwordx4 v[216:219], v4, s[52:55], s13 offen sc1
    v_cvt_pk_bf16_f32 v220, v130, v162
    v_cvt_pk_bf16_f32 v221, v146, v178
    v_cvt_pk_bf16_f32 v222, v131, v163
    v_cvt_pk_bf16_f32 v223, v147, v179
    s_mov_b32 s13, 1327104
    buffer_store_dwordx4 v[220:223], v4, s[52:55], s13 offen sc1
    v_cvt_pk_bf16_f32 v224, v132, v164
    v_cvt_pk_bf16_f32 v225, v148, v180
    v_cvt_pk_bf16_f32 v226, v133, v165
    v_cvt_pk_bf16_f32 v227, v149, v181
    s_mov_b32 s13, 1769472
    buffer_store_dwordx4 v[224:227], v4, s[52:55], s13 offen sc1
    v_cvt_pk_bf16_f32 v228, v134, v166
    v_cvt_pk_bf16_f32 v229, v150, v182
    v_cvt_pk_bf16_f32 v230, v135, v167
    v_cvt_pk_bf16_f32 v231, v151, v183
    s_mov_b32 s13, 1916928
    buffer_store_dwordx4 v[228:231], v4, s[52:55], s13 offen sc1
    s_cmp_lg_u32 s14, 0
    s_cbranch_scc1 L_nospecial
    v_mfma_f32_32x32x16_bf16 v[120:135], v[72:75], v[104:107], 0
    v_mfma_f32_32x32x16_bf16 v[120:135], v[76:79], v[108:111], v[120:135]
    v_mfma_f32_32x32x16_bf16 v[136:151], v[72:75], v[112:115], 0
    v_mfma_f32_32x32x16_bf16 v[136:151], v[76:79], v[116:119], v[136:151]
    v_mfma_f32_32x32x16_bf16 v[152:167], v[80:83], v[104:107], 0
    v_mfma_f32_32x32x16_bf16 v[152:167], v[84:87], v[108:111], v[152:167]
    v_mfma_f32_32x32x16_bf16 v[168:183], v[80:83], v[112:115], 0
    v_mfma_f32_32x32x16_bf16 v[168:183], v[84:87], v[116:119], v[168:183]
    v_lshrrev_b32 v5, 1, v2
    s_mov_b32 s13, 147456
    v_mul_lo_u32 v5, s13, v5
    v_and_b32 v6, 1, v2
    v_lshl_add_u32 v5, v6, 3, v5
    s_lshl_b32 s13, s6, 1
    s_add_u32 s13, s13, s4
    s_mul_i32 s13, s13, 4608
    s_add_u32 s13, s13, 8392704
    s_nop 0
    v_cvt_pk_bf16_f32 v6, v120, v152
    s_nop 0
    v_cvt_pk_bf16_f32 v7, v136, v168
    s_mov_b32 exec_hi, 0
    buffer_store_dwordx2 v[6:7], v5, s[52:55], s13 offen sc1
    s_mov_b64 exec, -1
L_nospecial:
    s_barrier
    ds_read_b64_tr_b16 v[40:41], v242 offset:45056
    ds_read_b64_tr_b16 v[42:43], v242 offset:46080
    ds_read_b64_tr_b16 v[44:45], v243 offset:45056
    ds_read_b64_tr_b16 v[46:47], v243 offset:46080
    ds_read_b64_tr_b16 v[48:49], v242 offset:53248
    ds_read_b64_tr_b16 v[50:51], v242 offset:54272
    ds_read_b64_tr_b16 v[52:53], v243 offset:53248
    ds_read_b64_tr_b16 v[54:55], v243 offset:54272
    s_waitcnt lgkmcnt(4)
    ds_read_b64_tr_b16 v[56:57], v244 offset:61440
    ds_read_b64_tr_b16 v[58:59], v244 offset:62464
    ds_read_b64_tr_b16 v[60:61], v245 offset:61440
    ds_read_b64_tr_b16 v[62:63], v245 offset:62464
    ds_read_b64_tr_b16 v[64:65], v246 offset:4096
    ds_read_b64_tr_b16 v[66:67], v246 offset:5120
    ds_read_b64_tr_b16 v[68:69], v247 offset:4096
    ds_read_b64_tr_b16 v[70:71], v247 offset:5120
    s_waitcnt lgkmcnt(4)
    ds_read_b64_tr_b16 v[72:73], v246 offset:12288
    ds_read_b64_tr_b16 v[74:75], v246 offset:13312
    ds_read_b64_tr_b16 v[76:77], v247 offset:12288
    ds_read_b64_tr_b16 v[78:79], v247 offset:13312
    ds_read_b64_tr_b16 v[80:81], v246 offset:20480
    ds_read_b64_tr_b16 v[82:83], v246 offset:21504
    ds_read_b64_tr_b16 v[84:85], v247 offset:20480
    ds_read_b64_tr_b16 v[86:87], v247 offset:21504
    s_waitcnt lgkmcnt(4)
    ds_read_b64_tr_b16 v[88:89], v242 offset:12288
    ds_read_b64_tr_b16 v[90:91], v242 offset:13312
    ds_read_b64_tr_b16 v[92:93], v243 offset:12288
    ds_read_b64_tr_b16 v[94:95], v243 offset:13312
    ds_read_b64_tr_b16 v[96:97], v242 offset:20480
    ds_read_b64_tr_b16 v[98:99], v242 offset:21504
    ds_read_b64_tr_b16 v[100:101], v243 offset:20480
    ds_read_b64_tr_b16 v[102:103], v243 offset:21504
    s_waitcnt lgkmcnt(4)
    ds_read_b64_tr_b16 v[104:105], v242 offset:61440
    ds_read_b64_tr_b16 v[106:107], v242 offset:62464
    ds_read_b64_tr_b16 v[108:109], v243 offset:61440
    ds_read_b64_tr_b16 v[110:111], v243 offset:62464
    ds_read_b64_tr_b16 v[112:113], v244 offset:4096
    ds_read_b64_tr_b16 v[114:115], v244 offset:5120
    ds_read_b64_tr_b16 v[116:117], v245 offset:4096
    ds_read_b64_tr_b16 v[118:119], v245 offset:5120
    s_waitcnt lgkmcnt(0)
    s_barrier
    s_add_u32 m0, s80, 45056
    s_add_u32 s12, s18, 65536
    buffer_load_dwordx4 v237, s[64:67], s12 offen lds
    s_add_u32 m0, s80, 53248
    s_add_u32 s12, s18, 81920
    buffer_load_dwordx4 v237, s[64:67], s12 offen lds
    s_add_u32 m0, s80, 126976
    s_add_u32 s12, s19, 65536
    buffer_load_dwordx4 v237, s[64:67], s12 offen lds
    s_add_u32 m0, s80, 135168
    s_add_u32 s12, s19, 81920
    buffer_load_dwordx4 v237, s[64:67], s12 offen lds
    s_mov_b32 exec_lo, s82
    s_mov_b32 exec_hi, 0
    buffer_load_dword v6, v254, s[52:55], 0 offen sc1
    s_mov_b64 exec, -1
    s_add_u32 m0, s80, 143360
    s_add_u32 s12, s20, 65536
    buffer_load_dwordx4 v237, s[64:67], s12 offen lds
    s_add_u32 m0, s80, 151552
    s_add_u32 s12, s20, 81920
    buffer_load_dwordx4 v237, s[64:67], s12 offen lds
    s_waitcnt vmcnt(7)
    s_barrier
    v_mov_b32 v2, s30
    v_mov_b32 v3, 1
    s_mov_b64 exec, 1
    buffer_store_dword v3, v2, s[52:55], 0 offen sc1
    s_mov_b64 exec, -1
    s_waitcnt vmcnt(3)
    v_cmp_le_u32 vcc, 1, v6
    s_nop 0
    s_and_b32 s10, vcc_lo, s82
    s_cmp_eq_u32 s10, s82
    s_cbranch_scc1 L_hpdD
L_hpD:
    s_mov_b32 exec_lo, s82
    s_mov_b32 exec_hi, 0
    buffer_load_dword v6, v254, s[52:55], 0 offen sc1
    s_mov_b64 exec, -1
    s_waitcnt vmcnt(0)
    v_cmp_le_u32 vcc, 1, v6
    s_nop 0
    s_and_b32 s10, vcc_lo, s82
    s_cmp_eq_u32 s10, s82
    s_cbranch_scc1 L_hpdD
    s_add_u32 s84, s84, 1
    s_cmp_lt_u32 s84, 200000
    s_cbranch_scc1 L_hpD
L_hpdD:
    s_lshr_b32 s83, s16, 4
    s_add_u32 s83, s83, s81
    buffer_load_dwordx4 v[120:123], v236, s[52:55], s83 offen offset:0 sc1
    buffer_load_dwordx4 v[124:127], v236, s[52:55], s83 offen offset:1024 sc1
    s_lshr_b32 s83, s17, 4
    s_add_u32 s83, s83, s81
    buffer_load_dwordx4 v[128:131], v236, s[52:55], s83 offen offset:0 sc1
    buffer_load_dwordx4 v[132:135], v236, s[52:55], s83 offen offset:1024 sc1
    s_lshr_b32 s83, s18, 4
    s_add_u32 s83, s83, s81
    buffer_load_dwordx4 v[136:139], v236, s[52:55], s83 offen offset:0 sc1
    buffer_load_dwordx4 v[140:143], v236, s[52:55], s83 offen offset:1024 sc1
    s_lshr_b32 s83, s19, 4
    s_add_u32 s83, s83, s81
    buffer_load_dwordx4 v[144:147], v236, s[52:55], s83 offen offset:0 sc1
    s_waitcnt vmcnt(6)
    v_mfma_f32_32x32x16_bf16 v[184:199], v[40:43], v[120:123], 0
    v_mfma_f32_32x32x16_bf16 v[200:215], v[44:47], v[120:123], 0
    buffer_load_dwordx4 v[148:151], v236, s[52:55], s83 offen offset:1024 sc1
    s_add_u32 m0, s80, 12288
    s_add_u32 s12, s21, 65536
    buffer_load_dwordx4 v237, s[64:67], s12 offen lds
    s_waitcnt vmcnt(7)
    v_mfma_f32_32x32x16_bf16 v[184:199], v[48:51], v[124:127], v[184:199]
    v_mfma_f32_32x32x16_bf16 v[200:215], v[52:55], v[124:127], v[200:215]
    s_lshr_b32 s83, s20, 4
    s_add_u32 s83, s83, s81
    buffer_load_dwordx4 v[152:155], v236, s[52:55], s83 offen offset:0 sc1
    s_add_u32 m0, s80, 20480
    s_add_u32 s12, s21, 81920
    buffer_load_dwordx4 v237, s[64:67], s12 offen lds
    s_waitcnt vmcnt(8)
    v_mfma_f32_32x32x16_bf16 v[184:199], v[56:59], v[128:131], v[184:199]
    v_mfma_f32_32x32x16_bf16 v[200:215], v[60:63], v[128:131], v[200:215]
    buffer_load_dwordx4 v[156:159], v236, s[52:55], s83 offen offset:1024 sc1
    s_add_u32 m0, s80, 61440
    s_add_u32 s12, s22, 65536
    buffer_load_dwordx4 v237, s[64:67], s12 offen lds
    s_waitcnt vmcnt(9)
    v_mfma_f32_32x32x16_bf16 v[184:199], v[64:67], v[132:135], v[184:199]
    v_mfma_f32_32x32x16_bf16 v[200:215], v[68:71], v[132:135], v[200:215]
    s_lshr_b32 s83, s21, 4
    s_add_u32 s83, s83, s81
    buffer_load_dwordx4 v[120:123], v236, s[52:55], s83 offen offset:0 sc1
    s_add_u32 m0, s80, 69632
    s_add_u32 s12, s22, 81920
    buffer_load_dwordx4 v237, s[64:67], s12 offen lds
    s_waitcnt vmcnt(10)
    v_mfma_f32_32x32x16_bf16 v[184:199], v[72:75], v[136:139], v[184:199]
    v_mfma_f32_32x32x16_bf16 v[200:215], v[76:79], v[136:139], v[200:215]
    buffer_load_dwordx4 v[124:127], v236, s[52:55], s83 offen offset:1024 sc1
    s_add_u32 m0, s85, 0
    s_nop 0
    buffer_load_dwordx4 v238, s[56:59], 0 offen lds
    s_mov_b32 exec_lo, s82
    s_mov_b32 exec_hi, 0
    buffer_load_dword v5, v254, s[52:55], 0 offen sc1
    s_mov_b64 exec, -1
    s_waitcnt vmcnt(12)
    v_mfma_f32_32x32x16_bf16 v[184:199], v[80:83], v[140:143], v[184:199]
    v_mfma_f32_32x32x16_bf16 v[200:215], v[84:87], v[140:143], v[200:215]
    s_lshr_b32 s83, s22, 4
    s_add_u32 s83, s83, s81
    buffer_load_dwordx4 v[128:131], v236, s[52:55], s83 offen offset:0 sc1
    s_mul_i32 s12, s4, 147456
    s_add_u32 s12, s12, 8192
    s_add_u32 m0, s85, s12
    s_nop 0
    buffer_load_dwordx4 v238, s[60:63], 0 offen lds
    s_waitcnt vmcnt(13)
    v_mfma_f32_32x32x16_bf16 v[184:199], v[88:91], v[144:147], v[184:199]
    v_mfma_f32_32x32x16_bf16 v[200:215], v[92:95], v[144:147], v[200:215]
    buffer_load_dwordx4 v[132:135], v236, s[52:55], s83 offen offset:1024 sc1
    buffer_load_dwordx4 v[232:235], v241, s[40:43], 0 offen
    s_waitcnt vmcnt(4)
    v_cmp_le_u32 vcc, 2, v5
    s_nop 0
    s_and_b32 s10, vcc_lo, s82
    s_cmp_eq_u32 s10, s82
    s_cbranch_scc1 L_fastBD
    s_waitcnt vmcnt(14)
    v_mfma_f32_32x32x16_bf16 v[184:199], v[96:99], v[148:151], v[184:199]
    v_mfma_f32_32x32x16_bf16 v[200:215], v[100:103], v[148:151], v[200:215]
    ds_read_b64_tr_b16 v[224:225], v244 offset:12288
    ds_read_b64_tr_b16 v[226:227], v244 offset:13312
    ds_read_b64_tr_b16 v[228:229], v245 offset:12288
    ds_read_b64_tr_b16 v[230:231], v245 offset:13312
    s_waitcnt vmcnt(12)
    v_mfma_f32_32x32x16_bf16 v[184:199], v[104:107], v[152:155], v[184:199]
    v_mfma_f32_32x32x16_bf16 v[200:215], v[108:111], v[152:155], v[200:215]
    ds_read_b64_tr_b16 v[176:177], v244 offset:20480
    ds_read_b64_tr_b16 v[178:179], v244 offset:21504
    ds_read_b64_tr_b16 v[180:181], v245 offset:20480
    ds_read_b64_tr_b16 v[182:183], v245 offset:21504
    s_waitcnt vmcnt(10)
    v_mfma_f32_32x32x16_bf16 v[184:199], v[112:115], v[156:159], v[184:199]
    v_mfma_f32_32x32x16_bf16 v[200:215], v[116:119], v[156:159], v[200:215]
    ds_read_b64_tr_b16 v[216:217], v242 offset:28672
    ds_read_b64_tr_b16 v[218:219], v242 offset:29696
    ds_read_b64_tr_b16 v[220:221], v243 offset:28672
    ds_read_b64_tr_b16 v[222:223], v243 offset:29696
    s_waitcnt vmcnt(8) lgkmcnt(8)
    v_mfma_f32_32x32x16_bf16 v[184:199], v[224:227], v[120:123], v[184:199]
    v_mfma_f32_32x32x16_bf16 v[200:215], v[228:231], v[120:123], v[200:215]
    ds_read_b64_tr_b16 v[224:225], v242 offset:36864
    ds_read_b64_tr_b16 v[226:227], v242 offset:37888
    ds_read_b64_tr_b16 v[228:229], v243 offset:36864
    ds_read_b64_tr_b16 v[230:231], v243 offset:37888
    s_waitcnt vmcnt(6) lgkmcnt(8)
    v_mfma_f32_32x32x16_bf16 v[184:199], v[176:179], v[124:127], v[184:199]
    v_mfma_f32_32x32x16_bf16 v[200:215], v[180:183], v[124:127], v[200:215]
    ds_read_b64_tr_b16 v[176:177], v244 offset:28672
    ds_read_b64_tr_b16 v[178:179], v244 offset:29696
    ds_read_b64_tr_b16 v[180:181], v245 offset:28672
    ds_read_b64_tr_b16 v[182:183], v245 offset:29696
    s_waitcnt vmcnt(3) lgkmcnt(8)
    v_mfma_f32_32x32x16_bf16 v[184:199], v[216:219], v[128:131], v[184:199]
    v_mfma_f32_32x32x16_bf16 v[200:215], v[220:223], v[128:131], v[200:215]
    ds_read_b64_tr_b16 v[216:217], v244 offset:36864
    ds_read_b64_tr_b16 v[218:219], v244 offset:37888
    ds_read_b64_tr_b16 v[220:221], v245 offset:36864
    ds_read_b64_tr_b16 v[222:223], v245 offset:37888
    s_waitcnt vmcnt(1) lgkmcnt(8)
    v_mfma_f32_32x32x16_bf16 v[184:199], v[224:227], v[132:135], v[184:199]
    v_mfma_f32_32x32x16_bf16 v[200:215], v[228:231], v[132:135], v[200:215]
L_bpD:
    s_mov_b32 exec_lo, s82
    s_mov_b32 exec_hi, 0
    buffer_load_dword v5, v254, s[52:55], 0 offen sc1
    s_mov_b64 exec, -1
    s_waitcnt vmcnt(0)
    v_cmp_le_u32 vcc, 2, v5
    s_nop 0
    s_and_b32 s10, vcc_lo, s82
    s_cmp_eq_u32 s10, s82
    s_cbranch_scc1 L_bpdD
    s_add_u32 s84, s84, 1
    s_cmp_lt_u32 s84, 200000
    s_cbranch_scc1 L_bpD
L_bpdD:
    s_lshr_b32 s83, s16, 4
    s_add_u32 s83, s83, s79
    buffer_load_dwordx4 v[136:139], v236, s[52:55], s83 offen offset:0 sc1
    buffer_load_dwordx4 v[140:143], v236, s[52:55], s83 offen offset:1024 sc1
    s_lshr_b32 s83, s17, 4
    s_add_u32 s83, s83, s79
    buffer_load_dwordx4 v[144:147], v236, s[52:55], s83 offen offset:0 sc1
    buffer_load_dwordx4 v[148:151], v236, s[52:55], s83 offen offset:1024 sc1
    s_lshr_b32 s83, s18, 4
    s_add_u32 s83, s83, s79
    buffer_load_dwordx4 v[152:155], v236, s[52:55], s83 offen offset:0 sc1
    buffer_load_dwordx4 v[156:159], v236, s[52:55], s83 offen offset:1024 sc1
    s_lshr_b32 s83, s19, 4
    s_add_u32 s83, s83, s79
    buffer_load_dwordx4 v[120:123], v236, s[52:55], s83 offen offset:0 sc1
    s_branch L_joinBD
L_fastBD:
    s_waitcnt vmcnt(14)
    v_mfma_f32_32x32x16_bf16 v[184:199], v[96:99], v[148:151], v[184:199]
    v_mfma_f32_32x32x16_bf16 v[200:215], v[100:103], v[148:151], v[200:215]
    s_lshr_b32 s83, s16, 4
    s_add_u32 s83, s83, s79
    buffer_load_dwordx4 v[136:139], v236, s[52:55], s83 offen offset:0 sc1
    ds_read_b64_tr_b16 v[224:225], v244 offset:12288
    ds_read_b64_tr_b16 v[226:227], v244 offset:13312
    ds_read_b64_tr_b16 v[228:229], v245 offset:12288
    ds_read_b64_tr_b16 v[230:231], v245 offset:13312
    s_waitcnt vmcnt(13)
    v_mfma_f32_32x32x16_bf16 v[184:199], v[104:107], v[152:155], v[184:199]
    v_mfma_f32_32x32x16_bf16 v[200:215], v[108:111], v[152:155], v[200:215]
    buffer_load_dwordx4 v[140:143], v236, s[52:55], s83 offen offset:1024 sc1
    ds_read_b64_tr_b16 v[176:177], v244 offset:20480
    ds_read_b64_tr_b16 v[178:179], v244 offset:21504
    ds_read_b64_tr_b16 v[180:181], v245 offset:20480
    ds_read_b64_tr_b16 v[182:183], v245 offset:21504
    s_waitcnt vmcnt(12)
    v_mfma_f32_32x32x16_bf16 v[184:199], v[112:115], v[156:159], v[184:199]
    v_mfma_f32_32x32x16_bf16 v[200:215], v[116:119], v[156:159], v[200:215]
    s_lshr_b32 s83, s17, 4
    s_add_u32 s83, s83, s79
    buffer_load_dwordx4 v[144:147], v236, s[52:55], s83 offen offset:0 sc1
    ds_read_b64_tr_b16 v[216:217], v242 offset:28672
    ds_read_b64_tr_b16 v[218:219], v242 offset:29696
    ds_read_b64_tr_b16 v[220:221], v243 offset:28672
    ds_read_b64_tr_b16 v[222:223], v243 offset:29696
    s_waitcnt vmcnt(11) lgkmcnt(8)
    v_mfma_f32_32x32x16_bf16 v[184:199], v[224:227], v[120:123], v[184:199]
    v_mfma_f32_32x32x16_bf16 v[200:215], v[228:231], v[120:123], v[200:215]
    buffer_load_dwordx4 v[148:151], v236, s[52:55], s83 offen offset:1024 sc1
    ds_read_b64_tr_b16 v[224:225], v242 offset:36864
    ds_read_b64_tr_b16 v[226:227], v242 offset:37888
    ds_read_b64_tr_b16 v[228:229], v243 offset:36864
    ds_read_b64_tr_b16 v[230:231], v243 offset:37888
    s_waitcnt vmcnt(10) lgkmcnt(8)
    v_mfma_f32_32x32x16_bf16 v[184:199], v[176:179], v[124:127], v[184:199]
    v_mfma_f32_32x32x16_bf16 v[200:215], v[180:183], v[124:127], v[200:215]
    s_lshr_b32 s83, s18, 4
    s_add_u32 s83, s83, s79
    buffer_load_dwordx4 v[152:155], v236, s[52:55], s83 offen offset:0 sc1
    ds_read_b64_tr_b16 v[176:177], v244 offset:28672
    ds_read_b64_tr_b16 v[178:179], v244 offset:29696
    ds_read_b64_tr_b16 v[180:181], v245 offset:28672
    ds_read_b64_tr_b16 v[182:183], v245 offset:29696
    s_waitcnt vmcnt(8) lgkmcnt(8)
    v_mfma_f32_32x32x16_bf16 v[184:199], v[216:219], v[128:131], v[184:199]
    v_mfma_f32_32x32x16_bf16 v[200:215], v[220:223], v[128:131], v[200:215]
    buffer_load_dwordx4 v[156:159], v236, s[52:55], s83 offen offset:1024 sc1
    ds_read_b64_tr_b16 v[216:217], v244 offset:36864
    ds_read_b64_tr_b16 v[218:219], v244 offset:37888
    ds_read_b64_tr_b16 v[220:221], v245 offset:36864
    ds_read_b64_tr_b16 v[222:223], v245 offset:37888
    s_waitcnt vmcnt(7) lgkmcnt(8)
    v_mfma_f32_32x32x16_bf16 v[184:199], v[224:227], v[132:135], v[184:199]
    v_mfma_f32_32x32x16_bf16 v[200:215], v[228:231], v[132:135], v[200:215]
    s_lshr_b32 s83, s19, 4
    s_add_u32 s83, s83, s79
    buffer_load_dwordx4 v[120:123], v236, s[52:55], s83 offen offset:0 sc1
L_joinBD:
    s_mov_b32 exec_lo, 0
    buffer_load_dword v3, v254, s[52:55], 0 offen sc1
    s_mov_b64 exec, -1
    ds_read_b64_tr_b16 v[224:225], v244 offset:45056
    ds_read_b64_tr_b16 v[226:227], v244 offset:46080
    ds_read_b64_tr_b16 v[228:229], v245 offset:45056
    ds_read_b64_tr_b16 v[230:231], v245 offset:46080
    s_waitcnt vmcnt(7) lgkmcnt(8)
    v_mfma_f32_32x32x16_bf16 v[184:199], v[176:179], v[136:139], v[184:199]
    v_mfma_f32_32x32x16_bf16 v[200:215], v[180:183], v[136:139], v[200:215]
    buffer_load_dwordx4 v[124:127], v236, s[52:55], s83 offen offset:1024 sc1
    v_permlane32_swap_b32 v232, v234
    v_permlane32_swap_b32 v233, v235
    ds_read_b64_tr_b16 v[176:177], v244 offset:53248
    ds_read_b64_tr_b16 v[178:179], v244 offset:54272
    ds_read_b64_tr_b16 v[180:181], v245 offset:53248
    ds_read_b64_tr_b16 v[182:183], v245 offset:54272
    s_waitcnt vmcnt(7) lgkmcnt(8)
    v_mfma_f32_32x32x16_bf16 v[184:199], v[216:219], v[140:143], v[184:199]
    v_mfma_f32_32x32x16_bf16 v[200:215], v[220:223], v[140:143], v[200:215]
    s_lshr_b32 s83, s20, 4
    s_add_u32 s83, s83, s79
    buffer_load_dwordx4 v[128:131], v236, s[52:55], s83 offen offset:0 sc1
    v_lshlrev_b32 v160, 16, v232
    v_and_b32 v161, 0xffff0000, v232
    v_lshlrev_b32 v162, 16, v233
    v_and_b32 v163, 0xffff0000, v233
    v_lshlrev_b32 v164, 16, v234
    v_and_b32 v165, 0xffff0000, v234
    v_lshlrev_b32 v166, 16, v235
    v_and_b32 v167, 0xffff0000, v235
    s_barrier
    v_xor_b32 v2, 0, v248
    v_xor_b32 v4, 0, v239
    ds_read_b64_tr_b16 v[216:217], v242 offset:45056
    ds_read_b64_tr_b16 v[218:219], v242 offset:46080
    ds_read_b64_tr_b16 v[220:221], v243 offset:45056
    ds_read_b64_tr_b16 v[222:223], v243 offset:46080
    s_waitcnt vmcnt(7) lgkmcnt(8)
    v_mfma_f32_32x32x16_bf16 v[184:199], v[224:227], v[144:147], v[184:199]
    v_mfma_f32_32x32x16_bf16 v[200:215], v[228:231], v[144:147], v[200:215]
    ds_read_b64 v[88:89], v2
    ds_read_b64 v[90:91], v4
    buffer_load_dwordx4 v[132:135], v236, s[52:55], s83 offen offset:1024 sc1
    v_xor_b32 v2, 16, v248
    v_xor_b32 v4, 16, v239
    ds_read_b64_tr_b16 v[224:225], v242 offset:53248
    ds_read_b64_tr_b16 v[226:227], v242 offset:54272
    ds_read_b64_tr_b16 v[228:229], v243 offset:53248
    ds_read_b64_tr_b16 v[230:231], v243 offset:54272
    s_waitcnt vmcnt(7) lgkmcnt(10)
    v_mfma_f32_32x32x16_bf16 v[184:199], v[176:179], v[148:151], v[184:199]
    v_mfma_f32_32x32x16_bf16 v[200:215], v[180:183], v[148:151], v[200:215]
    ds_read_b64 v[92:93], v2
    ds_read_b64 v[94:95], v4
    s_lshr_b32 s83, s21, 4
    s_add_u32 s83, s83, s79
    buffer_load_dwordx4 v[136:139], v236, s[52:55], s83 offen offset:0 sc1
    v_xor_b32 v2, 32, v248
    v_xor_b32 v4, 32, v239
    ds_read_b64_tr_b16 v[176:177], v244 offset:61440
    ds_read_b64_tr_b16 v[178:179], v244 offset:62464
    ds_read_b64_tr_b16 v[180:181], v245 offset:61440
    ds_read_b64_tr_b16 v[182:183], v245 offset:62464
    s_waitcnt vmcnt(7) lgkmcnt(10)
    v_mfma_f32_32x32x16_bf16 v[184:199], v[216:219], v[152:155], v[184:199]
    v_mfma_f32_32x32x16_bf16 v[200:215], v[220:223], v[152:155], v[200:215]
    ds_read_b64 v[96:97], v2
    ds_read_b64 v[98:99], v4
    buffer_load_dwordx4 v[140:143], v236, s[52:55], s83 offen offset:1024 sc1
    v_swap_b32 v89, v90
    v_xor_b32 v2, 48, v248
    v_xor_b32 v4, 48, v239
    ds_read_b64_tr_b16 v[216:217], v246 offset:4096
    ds_read_b64_tr_b16 v[218:219], v246 offset:5120
    ds_read_b64_tr_b16 v[220:221], v247 offset:4096
    ds_read_b64_tr_b16 v[222:223], v247 offset:5120
    s_waitcnt vmcnt(7) lgkmcnt(10)
    v_mfma_f32_32x32x16_bf16 v[184:199], v[224:227], v[156:159], v[184:199]
    v_mfma_f32_32x32x16_bf16 v[200:215], v[228:231], v[156:159], v[200:215]
    ds_read_b64 v[100:101], v2
    ds_read_b64 v[102:103], v4
    s_lshr_b32 s83, s22, 4
    s_add_u32 s83, s83, s79
    buffer_load_dwordx4 v[144:147], v236, s[52:55], s83 offen offset:0 sc1
    v_swap_b32 v93, v94
    s_waitcnt vmcnt(6)
    v_cmp_ne_u32 vcc, 0, v3
    s_nop 0
    s_cmp_eq_u32 vcc_hi, -1
    s_cbranch_scc1 L_zpdD
L_zpD:
    s_sleep 12
    s_mov_b32 exec_lo, 0
    buffer_load_dword v3, v254, s[52:55], 0 offen sc1
    s_mov_b64 exec, -1
    s_waitcnt vmcnt(0)
    v_cmp_ne_u32 vcc, 0, v3
    s_nop 0
    s_cmp_eq_u32 vcc_hi, -1
    s_cbranch_scc1 L_zpdD
    s_add_u32 s84, s84, 1
    s_cmp_lt_u32 s84, 200000
    s_cbranch_scc1 L_zpD
L_zpdD:
    v_xor_b32 v2, 64, v248
    v_xor_b32 v4, 64, v239
    ds_read_b64_tr_b16 v[224:225], v246 offset:12288
    ds_read_b64_tr_b16 v[226:227], v246 offset:13312
    ds_read_b64_tr_b16 v[228:229], v247 offset:12288
    ds_read_b64_tr_b16 v[230:231], v247 offset:13312
    s_waitcnt vmcnt(7) lgkmcnt(10)
    v_mfma_f32_32x32x16_bf16 v[184:199], v[176:179], v[120:123], v[184:199]
    v_mfma_f32_32x32x16_bf16 v[200:215], v[180:183], v[120:123], v[200:215]
    ds_read_b64 v[104:105], v2
    ds_read_b64 v[106:107], v4
    buffer_load_dwordx4 v[148:151], v236, s[52:55], s83 offen offset:1024 sc1
    s_mov_b32 s10, 8388608
    buffer_load_dwordx4 v[56:59], v240, s[52:55], s10 offen sc1
    s_mov_b32 s10, 8407040
    buffer_load_dwordx4 v[60:63], v240, s[52:55], s10 offen sc1
    v_swap_b32 v97, v98
    v_xor_b32 v2, 80, v248
    v_xor_b32 v4, 80, v239
    ds_read_b64_tr_b16 v[176:177], v246 offset:20480
    ds_read_b64_tr_b16 v[178:179], v246 offset:21504
    ds_read_b64_tr_b16 v[180:181], v247 offset:20480
    ds_read_b64_tr_b16 v[182:183], v247 offset:21504
    s_waitcnt vmcnt(8) lgkmcnt(10)
    v_mfma_f32_32x32x16_bf16 v[184:199], v[216:219], v[124:127], v[184:199]
    v_mfma_f32_32x32x16_bf16 v[200:215], v[220:223], v[124:127], v[200:215]
    ds_read_b64 v[108:109], v2
    ds_read_b64 v[110:111], v4
    s_mov_b32 s10, 8425472
    buffer_load_dwordx4 v[64:67], v240, s[52:55], s10 offen sc1
    s_mov_b32 s10, 8443904
    buffer_load_dwordx4 v[68:71], v240, s[52:55], s10 offen sc1
    v_swap_b32 v101, v102
    v_xor_b32 v2, 96, v248
    v_xor_b32 v4, 96, v239
    ds_read_b64_tr_b16 v[216:217], v242 offset:12288
    ds_read_b64_tr_b16 v[218:219], v242 offset:13312
    ds_read_b64_tr_b16 v[220:221], v243 offset:12288
    ds_read_b64_tr_b16 v[222:223], v243 offset:13312
    s_waitcnt vmcnt(9) lgkmcnt(10)
    v_mfma_f32_32x32x16_bf16 v[184:199], v[224:227], v[128:131], v[184:199]
    v_mfma_f32_32x32x16_bf16 v[200:215], v[228:231], v[128:131], v[200:215]
    ds_read_b64 v[112:113], v2
    ds_read_b64 v[114:115], v4
    s_mov_b32 s10, 8462336
    buffer_load_dwordx4 v[72:75], v240, s[52:55], s10 offen sc1
    s_mov_b32 s10, 8480768
    buffer_load_dwordx4 v[76:79], v240, s[52:55], s10 offen sc1
    v_swap_b32 v105, v106
    v_xor_b32 v2, 112, v248
    v_xor_b32 v4, 112, v239
    ds_read_b64_tr_b16 v[224:225], v242 offset:20480
    ds_read_b64_tr_b16 v[226:227], v242 offset:21504
    ds_read_b64_tr_b16 v[228:229], v243 offset:20480
    ds_read_b64_tr_b16 v[230:231], v243 offset:21504
    s_waitcnt vmcnt(10) lgkmcnt(10)
    v_mfma_f32_32x32x16_bf16 v[184:199], v[176:179], v[132:135], v[184:199]
    v_mfma_f32_32x32x16_bf16 v[200:215], v[180:183], v[132:135], v[200:215]
    ds_read_b64 v[116:117], v2
    ds_read_b64 v[118:119], v4
    s_mov_b32 s10, 8499200
    buffer_load_dwordx4 v[80:83], v240, s[52:55], s10 offen sc1
    s_mov_b32 s10, 8517632
    buffer_load_dwordx4 v[84:87], v240, s[52:55], s10 offen sc1
    v_swap_b32 v109, v110
    ds_read_b64_tr_b16 v[176:177], v242 offset:61440
    ds_read_b64_tr_b16 v[178:179], v242 offset:62464
    ds_read_b64_tr_b16 v[180:181], v243 offset:61440
    ds_read_b64_tr_b16 v[182:183], v243 offset:62464
    s_waitcnt vmcnt(11) lgkmcnt(10)
    v_mfma_f32_32x32x16_bf16 v[184:199], v[216:219], v[136:139], v[184:199]
    v_mfma_f32_32x32x16_bf16 v[200:215], v[220:223], v[136:139], v[200:215]
    v_swap_b32 v113, v114
    ds_read_b64_tr_b16 v[216:217], v244 offset:4096
    ds_read_b64_tr_b16 v[218:219], v244 offset:5120
    ds_read_b64_tr_b16 v[220:221], v245 offset:4096
    ds_read_b64_tr_b16 v[222:223], v245 offset:5120
    s_waitcnt vmcnt(10) lgkmcnt(8)
    v_mfma_f32_32x32x16_bf16 v[184:199], v[224:227], v[140:143], v[184:199]
    v_mfma_f32_32x32x16_bf16 v[200:215], v[228:231], v[140:143], v[200:215]
    v_swap_b32 v117, v118
    s_waitcnt vmcnt(9) lgkmcnt(4)
    v_mfma_f32_32x32x16_bf16 v[184:199], v[176:179], v[144:147], v[184:199]
    v_mfma_f32_32x32x16_bf16 v[200:215], v[180:183], v[144:147], v[200:215]
    s_waitcnt vmcnt(8) lgkmcnt(0)
    v_mfma_f32_32x32x16_bf16 v[184:199], v[216:219], v[148:151], v[184:199]
    v_mfma_f32_32x32x16_bf16 v[200:215], v[220:223], v[148:151], v[200:215]
    s_nop 10
    ds_write_b128 v249, v[192:195] offset:12288
    ds_write_b128 v249, v[196:199] offset:20480
    ds_write_b128 v250, v[200:203] offset:28672
    ds_write_b128 v250, v[204:207] offset:36864
    ds_write_b128 v251, v[208:211] offset:28672
    ds_write_b128 v251, v[212:215] offset:36864
    s_waitcnt lgkmcnt(0)
    s_barrier
    ds_read_b128 v[192:195], v252 offset:12288
    ds_read_b128 v[196:199], v252 offset:20480
    ds_read_b128 v[200:203], v253 offset:28672
    ds_read_b128 v[204:207], v253 offset:36864
    ds_read_b128 v[208:211], v255 offset:28672
    ds_read_b128 v[212:215], v255 offset:36864
    s_waitcnt vmcnt(4)
    v_permlane16_swap_b32 v56, v58
    v_permlane16_swap_b32 v57, v59
    v_permlane16_swap_b32 v60, v62
    v_permlane16_swap_b32 v61, v63
    v_permlane16_swap_b32 v64, v66
    v_permlane16_swap_b32 v65, v67
    v_permlane16_swap_b32 v68, v70
    v_permlane16_swap_b32 v69, v71
    v_mfma_f32_32x32x16_bf16 v[40:55], v[56:59], v[88:91], 0
    v_mfma_f32_32x32x16_bf16 v[40:55], v[60:63], v[92:95], v[40:55]
    v_mfma_f32_32x32x16_bf16 v[40:55], v[64:67], v[96:99], v[40:55]
    v_mfma_f32_32x32x16_bf16 v[40:55], v[68:71], v[100:103], v[40:55]
    s_waitcnt lgkmcnt(4)
    v_add_f32 v184, v184, v192
    v_add_f32 v185, v185, v193
    v_add_f32 v186, v186, v194
    v_add_f32 v187, v187, v195
    v_add_f32 v188, v188, v196
    v_add_f32 v189, v189, v197
    v_add_f32 v190, v190, v198
    v_add_f32 v191, v191, v199
    s_waitcnt lgkmcnt(0)
    v_add_f32 v200, v200, v208
    v_add_f32 v201, v201, v209
    v_add_f32 v202, v202, v210
    v_add_f32 v203, v203, v211
    v_add_f32 v204, v204, v212
    v_add_f32 v205, v205, v213
    v_add_f32 v206, v206, v214
    v_add_f32 v207, v207, v215
    v_add_f32 v184, v184, v200
    v_add_f32 v185, v185, v201
    v_add_f32 v186, v186, v202
    v_add_f32 v187, v187, v203
    v_add_f32 v188, v188, v204
    v_add_f32 v189, v189, v205
    v_add_f32 v190, v190, v206
    v_add_f32 v191, v191, v207
    s_waitcnt vmcnt(0)
    v_permlane16_swap_b32 v72, v74
    v_permlane16_swap_b32 v73, v75
    v_permlane16_swap_b32 v76, v78
    v_permlane16_swap_b32 v77, v79
    v_permlane16_swap_b32 v80, v82
    v_permlane16_swap_b32 v81, v83
    v_permlane16_swap_b32 v84, v86
    v_permlane16_swap_b32 v85, v87
    v_mfma_f32_32x32x16_bf16 v[40:55], v[72:75], v[104:107], v[40:55]
    v_mfma_f32_32x32x16_bf16 v[40:55], v[76:79], v[108:111], v[40:55]
    v_mfma_f32_32x32x16_bf16 v[40:55], v[80:83], v[112:115], v[40:55]
    v_mfma_f32_32x32x16_bf16 v[40:55], v[84:87], v[116:119], v[40:55]
    v_mul_f32 v168, 0xbfb8aa3b, v184
    v_mul_f32 v169, 0xbfb8aa3b, v185
    v_mul_f32 v170, 0xbfb8aa3b, v186
    v_mul_f32 v171, 0xbfb8aa3b, v187
    v_mul_f32 v172, 0xbfb8aa3b, v188
    v_mul_f32 v173, 0xbfb8aa3b, v189
    v_mul_f32 v174, 0xbfb8aa3b, v190
    v_mul_f32 v175, 0xbfb8aa3b, v191
    v_exp_f32 v168, v168
    v_exp_f32 v169, v169
    v_exp_f32 v170, v170
    v_exp_f32 v171, v171
    v_exp_f32 v172, v172
    v_exp_f32 v173, v173
    v_exp_f32 v174, v174
    v_exp_f32 v175, v175
    v_add_f32 v168, 1.0, v168
    v_add_f32 v169, 1.0, v169
    v_add_f32 v170, 1.0, v170
    v_add_f32 v171, 1.0, v171
    v_add_f32 v172, 1.0, v172
    v_add_f32 v173, 1.0, v173
    v_add_f32 v174, 1.0, v174
    v_add_f32 v175, 1.0, v175
    v_rcp_f32 v168, v168
    v_rcp_f32 v169, v169
    v_rcp_f32 v170, v170
    v_rcp_f32 v171, v171
    v_rcp_f32 v172, v172
    v_rcp_f32 v173, v173
    v_rcp_f32 v174, v174
    v_rcp_f32 v175, v175
    v_mul_f32 v168, v168, v184
    v_mul_f32 v169, v169, v185
    v_mul_f32 v170, v170, v186
    v_mul_f32 v171, v171, v187
    v_mul_f32 v172, v172, v188
    v_mul_f32 v173, v173, v189
    v_mul_f32 v174, v174, v190
    v_mul_f32 v175, v175, v191
    v_fma_f32 v160, v40, v168, v160
    v_fma_f32 v161, v41, v169, v161
    v_fma_f32 v162, v42, v170, v162
    v_fma_f32 v163, v43, v171, v163
    v_fma_f32 v164, v44, v172, v164
    v_fma_f32 v165, v45, v173, v165
    v_fma_f32 v166, v46, v174, v166
    v_fma_f32 v167, v47, v175, v167
    v_cvt_pk_bf16_f32 v232, v160, v161
    v_cvt_pk_bf16_f32 v233, v162, v163
    v_cvt_pk_bf16_f32 v234, v164, v165
    v_cvt_pk_bf16_f32 v235, v166, v167
    s_nop 0
    v_permlane32_swap_b32 v232, v234
    v_permlane32_swap_b32 v233, v235
    buffer_store_dwordx4 v[232:235], v241, s[68:71], 0 offen
    s_endpgm
L_end:
    s_endpgm
L_code_end:
.section .rodata,"a"
.p2align 6
.amdhsa_kernel recurrent_scan__spectral_fnet__geglu_ffn__prompt_kernel
  .amdhsa_next_free_vgpr 256
  .amdhsa_next_free_sgpr 102
  .amdhsa_accum_offset 256
  .amdhsa_group_segment_fixed_size 0
  .amdhsa_kernarg_size 96
  .amdhsa_user_sgpr_count 2
  .amdhsa_user_sgpr_kernarg_segment_ptr 1
  .amdhsa_system_sgpr_workgroup_id_x 1
.end_amdhsa_kernel
```
